```python
import torch

def _softmax(x, axis=-1):
    return torch.softmax(x, dim=axis)
def _gelu(x):
    return torch.nn.functional.gelu(x, approximate="tanh")
def _silu(x):
    return torch.nn.functional.silu(x)
def _sigmoid(x):
    return torch.sigmoid(x)
def _layernorm(x, axis=-1, eps=1e-5):
    m = x.mean(dim=axis, keepdim=True)
    v = x.var(dim=axis, keepdim=True, unbiased=False)
    return (x - m) / torch.sqrt(v + eps)
def _scatter_add(tgt, idx, src, axis=0):
    return tgt.clone().index_add_(axis, idx, src)
def _segment_sum(src, seg, n):
    out = torch.zeros((n,) + src.shape[1:], dtype=src.dtype)
    return out.index_add_(0, seg, src)
def _pad(x, pw):
    flat = tuple(v for pair in reversed(pw) for v in pair)
    return torch.nn.functional.pad(x, flat)

kernel_name = 'standalone__mpnn_edge_mlp__graph'

def setup_inputs():

    _w = (lambda a: (lambda t: t.to(torch.bfloat16) if t.is_floating_point() else t)(torch.as_tensor(a)))
    N, deg, D, De = 12500, 32, 128, max(4, 1)
    E = N * deg
    return {
        "x": _w((lambda *s: torch.randn(*s, dtype=torch.bfloat16) * 0.05)(N, D)),
        "e_attr": _w((lambda *s: torch.randn(*s, dtype=torch.bfloat16) * 0.4)(E, De)),
        "src": _w((lambda lo, hi, *s: torch.randint(lo, hi, s))(0, N, E).to(torch.int64)),
        "dst": _w((lambda lo, hi, *s: torch.randint(lo, hi, s))(0, N, E).to(torch.int64)),
        "w_msg": _w((lambda *s: torch.randn(*s, dtype=torch.bfloat16) * 0.4)(2 * D + De, D)),
        "w_upd": _w((lambda *s: torch.randn(*s, dtype=torch.bfloat16) * 0.05)(2 * D, D)),
    }

def reference(x, e_attr, src, dst, w_msg, w_upd):
    N, D = x.shape
    m_in = torch.concatenate([x[src], x[dst], e_attr], axis=-1)
    msg = _silu(m_in @ w_msg)
    agg = _segment_sum(msg, dst, N)
    return _silu(torch.concatenate([x, agg], axis=-1) @ w_upd)
```

```asm
; @launch grid=(256,1,1) block=(512,1,1) lds=163840
.amdgcn_target "amdgcn-amd-amdhsa--gfx950"
.text
.globl standalone__mpnn_edge_mlp__graph_kernel
.p2align 8
.type standalone__mpnn_edge_mlp__graph_kernel,@function
standalone__mpnn_edge_mlp__graph_kernel:
    s_getpc_b64 s[86:87]
    s_cmp_ge_u32 s2, 256
    s_cbranch_scc1 KF_END
    s_load_dwordx16 s[4:19], s[0:1], 0
    s_load_dwordx2 s[20:21], s[0:1], 64
    v_lshrrev_b32 v1, 6, v0
    s_and_b32 s84, s2, 0xf8
    s_sub_u32 s85, s84, 144
    s_cselect_b32 s85, s84, s85
    v_add_lshl_u32 v2, v1, s85, 7
    v_readfirstlane_b32 s56, v1
    v_min_u32 v2, KF_CEND-standalone__mpnn_edge_mlp__graph_kernel-16, v2
    s_cmpk_eq_u32 s2, 0
    s_cbranch_scc1 KF_n0
    s_mov_b64 exec, 1
    global_load_dword v239, v2, s[86:87]
    s_mov_b64 exec, -1
KF_n1:
    v_and_b32 v157, 63, v0
    v_mov_b32 v238, 0
    v_lshlrev_b32 v113, 4, v157
    s_and_b32 s57, s2, 7
    s_lshl_b32 s57, s57, 5
    s_lshr_b32 s85, s2, 3
    s_or_b32 s57, s57, s85
    s_and_b32 s74, s56, 3
    s_lshl_b32 s22, s74, 10
    s_cmp_ge_u32 s56, 4
    s_cbranch_scc0 KF_S
    v_lshlrev_b32 v2, 2, v0
    v_lshlrev_b32 v3, 8, v157
    ds_write_b32 v2, v238 offset:59392
    v_lshlrev_b32 v2, 2, v157
    ds_write2st64_b32 v2, v3, v238 offset0:0 offset1:1
    v_bfe_u32 v1, v0, 4, 4
    v_xor_b32 v37, v1, v0
    v_and_b32 v37, 15, v37
    v_lshlrev_b32 v37, 4, v37
    v_lshl_add_u32 v36, v1, 8, s57
    s_waitcnt lgkmcnt(0)
    s_lshr_b32 s84, s84, 1
    s_add_u32 s84, s84, s56
    s_sub_u32 s84, s84, 4
    s_lshl_b32 s84, s84, 9
    v_lshl_add_u32 v2, v157, 7, s84
    s_mov_b64 exec, 15
    global_load_dword v239, v2, s[12:13]
    global_load_dword v239, v2, s[14:15]
    s_mov_b64 exec, -1
    s_branch KF_B0
KF_n0:
    s_memrealtime s[44:45]
    v_and_b32 v2, 63, v0
    v_lshlrev_b32 v2, 2, v2
    s_cmp_eq_u32 s56, 4
    s_waitcnt lgkmcnt(0)
    s_cbranch_scc0 KF_n1
    s_lshl_b32 s46, s44, 2
    s_or_b32 s46, s46, 1
    v_mov_b32 v3, s46
    s_mov_b64 exec, -1
    global_store_dword v2, v3, s[18:19] sc1
    s_mov_b64 exec, -1
    s_branch KF_n1
KF_S:
    s_min_u32 s86, s2, 249
    s_mul_i32 s86, s86, 6400
    s_mul_i32 s87, s56, 400
    v_add_u32 v108, s87, v157
    v_lshlrev_b32 v109, 2, v108
    s_mov_b32 s42, 1600000
    s_mov_b32 s43, 0x00020000
    s_waitcnt lgkmcnt(0)
    s_mov_b32 s40, s10
    s_and_b32 s41, s11, 0xffff
    buffer_load_dword v28, v109, s[40:43], s86 offen offset:0
    buffer_load_dword v29, v109, s[40:43], s86 offen offset:256
    buffer_load_dword v30, v109, s[40:43], s86 offen offset:512
    buffer_load_dword v31, v109, s[40:43], s86 offen offset:768
    buffer_load_dword v32, v109, s[40:43], s86 offen offset:1024
    buffer_load_dword v33, v109, s[40:43], s86 offen offset:1280
    s_mov_b64 exec, 0xffff
    buffer_load_dword v34, v109, s[40:43], s86 offen offset:1536
    s_mov_b64 exec, -1
    s_mov_b32 s44, s8
    s_and_b32 s45, s9, 0xffff
    s_mov_b32 s46, 1600000
    s_mov_b32 s47, 0x00020000
    buffer_load_dword v36, v109, s[44:47], s86 offen offset:0
    buffer_load_dword v37, v109, s[44:47], s86 offen offset:256
    buffer_load_dword v38, v109, s[44:47], s86 offen offset:512
    buffer_load_dword v39, v109, s[44:47], s86 offen offset:768
    buffer_load_dword v40, v109, s[44:47], s86 offen offset:1024
    buffer_load_dword v41, v109, s[44:47], s86 offen offset:1280
    s_mov_b64 exec, 0xffff
    buffer_load_dword v42, v109, s[44:47], s86 offen offset:1536
    s_mov_b64 exec, -1
KF_B0:
    s_lshl_b32 s61, s56, 13
    s_add_u32 s61, s61, 98304
    s_barrier
    s_add_u32 s24, s20, 0x3480400
    s_addc_u32 s25, s21, 0
    s_and_b32 s25, s25, 0xffff
    s_or_b32 s25, s25, 0x1000000
    s_mov_b32 s26, 12500
    s_mov_b32 s27, 0x00020000
    s_mov_b32 s36, s20
    s_and_b32 s37, s21, 0xffff
    s_mov_b32 s38, 268435456
    s_mov_b32 s39, 0x00020000
    s_cmp_lt_u32 s57, 212
    s_cselect_b32 s58, 49, 48
    s_mov_b32 s66, 0xbfb8aa3b
    s_mov_b32 s67, 0xbfb8aa3b
    s_mov_b32 s68, 16
    s_mov_b32 s69, 16
    s_mov_b32 s78, 0x0000ffff
    s_mov_b32 s79, 0x0000ffff
    s_mov_b32 s80, 33792
    s_mov_b32 s73, 400000
    v_lshrrev_b32 v2, 5, v157
    v_lshrrev_b32 v1, 3, v157
    v_and_b32 v1, 2, v1
    v_and_or_b32 v1, v157, 5, v1
    v_lshlrev_b32 v152, 1, v1
    v_lshlrev_b32 v3, 1, v157
    v_and_b32 v3, 4, v3
    v_and_or_b32 v236, v157, 8, v3
    v_lshlrev_b32 v237, 1, v236
    v_add_u32 v237, 72976, v237
    v_and_b32 v158, 15, v157
    v_lshlrev_b32 v3, 1, v3
    v_and_or_b32 v3, v157, 1, v3
    v_lshl_or_b32 v3, v2, 2, v3
    v_lshl_add_u32 v144, v3, 7, s61
    v_bfe_u32 v1, v157, 1, 1
    v_bfe_u32 v3, v157, 2, 3
    v_xor_b32 v1, v1, v3
    v_lshl_add_u32 v144, v1, 4, v144
    v_mul_i32_i24 v156, -8, v2
    v_mul_u32_u24 v154, 944, v158
    v_and_b32 v1, 1, v157
    v_lshlrev_b32 v1, 4, v1
    v_mov_b32 v3, 0x3f80
    v_lshlrev_b32 v1, v1, v3
    s_mov_b32 vcc_lo, 0x33333333
    s_mov_b32 vcc_hi, 0x33333333
    v_cndmask_b32 v4, 0, v1, vcc
    v_sub_u32 v5, v1, v4
    v_lshrrev_b32 v2, 4, v157
    v_lshrrev_b32 v153, 2, v157
    v_and_b32 v153, 14, v153
    v_and_b32 v1, 7, v157
    v_lshlrev_b32 v1, 4, v1
    s_movk_i32 s81, 128
    v_xor_b32 v129, 3072, v1
    v_xor_b32 v131, 2064, v1
    v_xor_b32 v133, 1024, v1
    v_xor_b32 v135, 16, v1
    v_xor_b32 v3, v2, v158
    v_lshlrev_b32 v3, 4, v3
    v_lshl_add_u32 v3, v158, 8, v3
    v_add_u32 v252, 17408, v3
    v_xor_b32 v253, 64, v252
    v_xor_b32 v254, 128, v252
    v_xor_b32 v255, 192, v252
    s_lshl_b32 s84, s74, 13
    s_add_u32 s84, s84, 98304
    s_lshr_b32 s85, s56, 2
    v_lshrrev_b32 v1, 2, v158
    v_lshl_add_u32 v1, v2, 3, v1
    v_lshl_add_u32 v159, v1, 6, s84
    v_xor_b32 v2, s85, v2
    v_and_b32 v2, 1, v2
    v_and_b32 v3, 3, v157
    v_lshl_add_u32 v240, v2, 5, v159
    v_lshl_add_u32 v240, v3, 3, v240
    v_lshrrev_b32 v2, 3, v157
    v_and_b32 v2, 2, v2
    v_xor_b32 v2, v2, v3
    v_lshl_add_u32 v143, v2, 4, v159
    s_cmp_ge_u32 s56, 4
    s_cbranch_scc1 KF_T
    s_mov_b32 s48, s6
    s_and_b32 s49, s7, 0xffff
    s_mov_b32 s50, 3200000
    s_mov_b32 s51, 0x00020000
    s_lshl_b32 s75, s87, 3
    s_lshl_b32 s86, s86, 1
    s_add_u32 s86, s86, s75
    s_add_u32 m0, s75, 46592
    s_add_u32 s75, s75, 33792
    buffer_load_dwordx4 v113, s[48:51], s86 offen offset:0 lds
    buffer_load_dwordx4 v113, s[48:51], s86 offen offset:1024 lds
    buffer_load_dwordx4 v113, s[48:51], s86 offen offset:2048 lds
    s_mov_b64 exec, 0xff
    buffer_load_dwordx4 v113, s[48:51], s86 offen offset:3072 lds
    s_mov_b64 exec, -1
    v_mov_b32 v111, 8
    v_and_b32 v124, 7, v157
    v_lshlrev_b32 v124, 7, v124
    v_lshrrev_b32 v125, 3, v157
    v_lshl_add_u32 v124, v125, 2, v124
    v_add_u32 v124, 60416, v124
    v_add_u32 v125, 1024, v124
    v_lshlrev_b32 v112, 3, v108
    v_lshlrev_b32 v110, 4, v108
    v_add_u32 v61, 0, v112
    v_add_u32 v63, 512, v112
    v_add_u32 v65, 1024, v112
    v_add_u32 v67, 1536, v112
    v_add_u32 v69, 2048, v112
    v_add_u32 v71, 2560, v112
    v_add_u32 v73, 3072, v112
    s_cmp_ge_u32 s2, 250
    s_cbranch_scc1 KS_d
    s_waitcnt vmcnt(11)
    v_lshlrev_b32_sdwa v44, 2, v28 dst_sel:DWORD dst_unused:UNUSED_PAD src0_sel:DWORD src1_sel:BYTE_0
    ds_add_rtn_u32 v52, v44, v111 offset:60416
    v_lshlrev_b32_sdwa v45, 2, v29 dst_sel:DWORD dst_unused:UNUSED_PAD src0_sel:DWORD src1_sel:BYTE_0
    ds_add_rtn_u32 v53, v45, v111 offset:60416
    v_lshlrev_b32_sdwa v46, 2, v30 dst_sel:DWORD dst_unused:UNUSED_PAD src0_sel:DWORD src1_sel:BYTE_0
    ds_add_rtn_u32 v54, v46, v111 offset:60416
    v_lshlrev_b32_sdwa v47, 2, v31 dst_sel:DWORD dst_unused:UNUSED_PAD src0_sel:DWORD src1_sel:BYTE_0
    ds_add_rtn_u32 v55, v47, v111 offset:60416
    v_lshlrev_b32_sdwa v48, 2, v32 dst_sel:DWORD dst_unused:UNUSED_PAD src0_sel:DWORD src1_sel:BYTE_0
    ds_add_rtn_u32 v56, v48, v111 offset:60416
    v_lshlrev_b32_sdwa v49, 2, v33 dst_sel:DWORD dst_unused:UNUSED_PAD src0_sel:DWORD src1_sel:BYTE_0
    ds_add_rtn_u32 v57, v49, v111 offset:60416
    s_mov_b64 exec, 0xffff
    v_lshlrev_b32_sdwa v50, 2, v34 dst_sel:DWORD dst_unused:UNUSED_PAD src0_sel:DWORD src1_sel:BYTE_0
    ds_add_rtn_u32 v58, v50, v111 offset:60416
    s_mov_b64 exec, -1
KS_d:
    v_mov_b32 v2, 1
    s_mov_b64 exec, 1
    ds_add_u32 v238, v2 offset:260
    s_mov_b64 exec, -1
KS_y1:
    ds_read_b32 v2, v238 offset:260
    s_waitcnt lgkmcnt(0)
    v_readfirstlane_b32 s85, v2
    s_and_b32 s85, s85, 255
    s_cmp_lt_u32 s85, 4
    s_cbranch_scc1 KS_y1
    ds_read_b128 v[116:119], v113 offset:60416
    s_load_dword s72, s[18:19], 0
    v_lshrrev_b32 v28, 8, v28
    v_lshrrev_b32 v29, 8, v29
    v_lshrrev_b32 v30, 8, v30
    v_lshrrev_b32 v31, 8, v31
    v_lshrrev_b32 v32, 8, v32
    v_lshrrev_b32 v33, 8, v33
    v_lshrrev_b32 v34, 8, v34
    s_waitcnt lgkmcnt(0)
    v_add_u32 v2, v116, v117
    v_add3_u32 v2, v2, v118, v119
    v_mov_b32 v3, v2
    s_nop 1
    v_add_u32_dpp v3, v3, v3 row_shr:1 row_mask:0xf bank_mask:0xf bound_ctrl:0
    s_nop 1
    v_add_u32_dpp v3, v3, v3 row_shr:2 row_mask:0xf bank_mask:0xf bound_ctrl:0
    s_nop 1
    v_add_u32_dpp v3, v3, v3 row_shr:4 row_mask:0xf bank_mask:0xf bound_ctrl:0
    s_nop 1
    v_add_u32_dpp v3, v3, v3 row_shr:8 row_mask:0xf bank_mask:0xf bound_ctrl:0
    s_nop 1
    v_add_u32_dpp v3, v3, v3 row_bcast:15 row_mask:0xa bank_mask:0xf
    s_nop 1
    v_add_u32_dpp v3, v3, v3 row_bcast:31 row_mask:0xc bank_mask:0xf
    s_nop 1
    v_sub_u32 v120, v3, v2
    v_add_u32 v121, v120, v116
    v_add_u32 v122, v121, v117
    v_add_u32 v123, v122, v118
    ds_write_b128 v113, v[120:123] offset:61440
    ds_read_b32 v44, v44 offset:61440
    ds_read_b32 v45, v45 offset:61440
    ds_read_b32 v46, v46 offset:61440
    ds_read_b32 v47, v47 offset:61440
    ds_read_b32 v48, v48 offset:61440
    ds_read_b32 v49, v49 offset:61440
    s_mov_b64 exec, 0xffff
    ds_read_b32 v50, v50 offset:61440
    s_mov_b64 exec, -1
    v_mov_b32 v226, v3
    v_lshl_or_b32 v224, v121, 16, v120
    v_lshl_or_b32 v225, v123, 16, v122
    s_lshl_b32 s86, s2, 10
    s_add_u32 s86, s86, 0
    s_lshl_b32 s87, s56, 4
    s_waitcnt lgkmcnt(0)
    s_cmp_lg_u32 s72, 0
    s_cbranch_scc1 KS_n1
    s_sleep 5
    s_load_dword s72, s[18:19], 128
    s_waitcnt lgkmcnt(0)
    s_cmp_lg_u32 s72, 0
    s_cbranch_scc1 KS_n1
    s_sleep 5
    s_load_dword s72, s[18:19], 64
    s_waitcnt lgkmcnt(0)
    s_cmp_lg_u32 s72, 0
    s_cbranch_scc1 KS_n1
    s_sleep 5
    s_load_dword s72, s[18:19], 192
    s_waitcnt lgkmcnt(0)
    s_cmp_lg_u32 s72, 0
    s_cbranch_scc1 KS_n1
KS_n0:
    global_load_dword v1, v238, s[18:19] sc1
    s_waitcnt vmcnt(0)
    v_readfirstlane_b32 s72, v1
    s_cmp_lg_u32 s72, 0
    s_cbranch_scc1 KS_n1
    s_sub_u32 s73, s73, 1
    s_cbranch_scc0 KS_n0
    s_mov_b32 s73, 0
    s_mov_b32 s72, 1
KS_n1:
    v_mov_b32 v1, s72
    ds_write_b32 v238, v1 offset:312
    s_mul_i32 s23, s72, 0x9E3779B1
    s_mul_i32 s59, s23, 0x85EBCA6B
    s_mul_hi_u32 s23, s23, 65
    s_mul_hi_u32 s59, s59, 8
    s_mul_i32 s23, s23, 3276800
    s_mul_i32 s59, s59, 6881280
    s_add_u32 s24, s24, s23
    s_addc_u32 s25, s25, 0
    v_mov_b32 v227, v1
    s_add_u32 s86, s86, s59
    s_lshl_b64 exec, 0xffff, s87
    buffer_store_dwordx4 v[224:227], v113, s[36:39], s86 offen sc1
    s_mov_b64 exec, -1
    v_mov_b32 v2, 1
    s_mov_b64 exec, 1
    ds_add_u32 v238, v2 offset:316
    s_mov_b64 exec, -1
    s_cmp_ge_u32 s2, 250
    s_cbranch_scc1 KS_e
    s_waitcnt vmcnt(5)
    v_lshl_or_b32 v60, v28, 19, v36
    v_lshl_or_b32 v62, v29, 19, v37
    v_lshl_or_b32 v64, v30, 19, v38
    v_lshl_or_b32 v66, v31, 19, v39
    v_lshl_or_b32 v68, v32, 19, v40
    v_lshl_or_b32 v70, v33, 19, v41
    v_lshl_or_b32 v72, v34, 19, v42
    s_waitcnt lgkmcnt(0)
    v_add_u32 v44, v44, v52
    ds_write_b64 v44, v[60:61] offset:33792
    v_add_u32 v45, v45, v53
    ds_write_b64 v45, v[62:63] offset:33792
    v_add_u32 v46, v46, v54
    ds_write_b64 v46, v[64:65] offset:33792
    v_add_u32 v47, v47, v55
    ds_write_b64 v47, v[66:67] offset:33792
    v_add_u32 v48, v48, v56
    ds_write_b64 v48, v[68:69] offset:33792
    v_add_u32 v49, v49, v57
    ds_write_b64 v49, v[70:71] offset:33792
    s_mov_b64 exec, 0xffff
    v_add_u32 v50, v50, v58
    ds_write_b64 v50, v[72:73] offset:33792
    s_mov_b64 exec, -1
KS_e:
    v_lshlrev_b32 v114, 10, v0
    s_lshr_b32 s77, s57, 2
    s_lshl_b32 s77, s77, 4
    s_add_u32 s77, s77, 0
    s_add_u32 s77, s77, s59
    s_add_u32 s59, s59, 262144
    v_cmp_gt_u32 vcc, 250, v0
    v_mov_b32 v228, 0
    v_mov_b32 v229, 0
    v_mov_b32 v230, 0
    s_mul_i32 s84, s2, 25600
    s_add_u32 s84, s84, s59
    s_add_u32 s86, s84, 4096
    v_mul_u32_u24 v115, 25600, v0
    v_add_u32 v115, s59, v115
    s_waitcnt vmcnt(1)
    v_mov_b32 v2, 1
    s_mov_b64 exec, 1
    ds_add_u32 v238, v2 offset:260
    s_mov_b64 exec, -1
KS_y2:
    ds_read_b32 v2, v238 offset:260
    s_waitcnt lgkmcnt(0)
    v_readfirstlane_b32 s85, v2
    s_and_b32 s85, s85, 255
    s_cmp_lt_u32 s85, 8
    s_cbranch_scc1 KS_y2
    s_cmp_ge_u32 s2, 250
    s_cbranch_scc0 KS_h0
    s_branch KS_h1_
KS_h1:
    s_sleep 1
KS_h1_:
    ds_read_b32 v2, v238 offset:268
    s_waitcnt lgkmcnt(0)
    v_readfirstlane_b32 s85, v2
    s_and_b32 s85, s85, 255
    s_cmp_lt_u32 s85, 4
    s_cbranch_scc1 KS_h1
    s_mov_b64 exec, vcc
    buffer_load_dwordx4 v[228:231], v114, s[36:39], s77 offen sc1
    s_mov_b64 exec, -1
    s_waitcnt vmcnt(0)
    v_mov_b32 v1, 0
    s_branch KS_j
KS_h0:
    s_mov_b64 exec, 0xffff
    ds_read_b64 v[106:107], v112 offset:36864
    s_mov_b64 exec, -1
    ds_read_b64 v[82:83], v112 offset:33792
    ds_read_b64 v[86:87], v112 offset:34304
    ds_read_b64 v[90:91], v112 offset:34816
    ds_read_b64 v[94:95], v112 offset:35328
    ds_read_b64 v[98:99], v112 offset:35840
    ds_read_b64 v[102:103], v112 offset:36352
    s_mov_b64 exec, 0xffff
    s_waitcnt lgkmcnt(6)
    ds_read_b64 v[104:105], v107 offset:46592
    s_mov_b64 exec, -1
    s_waitcnt lgkmcnt(6)
    ds_read_b64 v[80:81], v83 offset:46592
    s_waitcnt lgkmcnt(6)
    ds_read_b64 v[84:85], v87 offset:46592
    s_waitcnt lgkmcnt(6)
    ds_read_b64 v[88:89], v91 offset:46592
    s_waitcnt lgkmcnt(6)
    ds_read_b64 v[92:93], v95 offset:46592
    s_waitcnt lgkmcnt(6)
    ds_read_b64 v[96:97], v99 offset:46592
    s_waitcnt lgkmcnt(6)
    ds_read_b64 v[100:101], v103 offset:46592
    s_branch KS_ww_
KS_ww:
    s_sleep 1
KS_ww_:
    ds_read_b32 v2, v238 offset:300
    s_waitcnt lgkmcnt(0)
    v_readfirstlane_b32 s85, v2
    s_and_b32 s85, s85, 255
    s_cmp_lt_u32 s85, 4
    s_cbranch_scc1 KS_ww
    s_mov_b64 exec, 0xffff
    v_mov_b32 v107, v1
    buffer_store_dwordx4 v[104:107], v110, s[36:39], s86 offen offset:2048 sc1
    s_mov_b64 exec, -1
    v_mov_b32 v83, v1
    buffer_store_dwordx4 v[80:83], v110, s[36:39], s84 offen offset:0 sc1
    v_mov_b32 v87, v1
    buffer_store_dwordx4 v[84:87], v110, s[36:39], s84 offen offset:1024 sc1
    v_mov_b32 v91, v1
    buffer_store_dwordx4 v[88:91], v110, s[36:39], s84 offen offset:2048 sc1
    v_mov_b32 v95, v1
    buffer_store_dwordx4 v[92:95], v110, s[36:39], s84 offen offset:3072 sc1
    v_mov_b32 v99, v1
    buffer_store_dwordx4 v[96:99], v110, s[36:39], s86 offen offset:0 sc1
    v_mov_b32 v103, v1
    buffer_store_dwordx4 v[100:103], v110, s[36:39], s86 offen offset:1024 sc1
    s_mov_b64 exec, vcc
    buffer_load_dwordx4 v[228:231], v114, s[36:39], s77 offen sc1
    s_mov_b64 exec, -1
    v_pk_maximum3_f16 v1, v80, v81, v81
    v_pk_minimum3_f16 v2, v80, v81, v81
    v_pk_maximum3_f16 v1, v1, v84, v85
    v_pk_minimum3_f16 v2, v2, v84, v85
    v_pk_maximum3_f16 v1, v1, v88, v89
    v_pk_minimum3_f16 v2, v2, v88, v89
    v_pk_maximum3_f16 v1, v1, v92, v93
    v_pk_minimum3_f16 v2, v2, v92, v93
    v_pk_maximum3_f16 v1, v1, v96, v97
    v_pk_minimum3_f16 v2, v2, v96, v97
    v_pk_maximum3_f16 v1, v1, v100, v101
    v_pk_minimum3_f16 v2, v2, v100, v101
    s_mov_b64 exec, 0xffff
    v_pk_maximum3_f16 v1, v1, v104, v105
    v_pk_minimum3_f16 v2, v2, v104, v105
    s_mov_b64 exec, -1
    v_and_b32 v1, 0x7fff7fff, v1
    v_and_b32 v2, 0x7fff7fff, v2
    v_pk_max_u16 v1, v1, v2
    v_lshlrev_b32 v3, 16, v1
    v_and_b32 v1, 0xffff0000, v1
    v_max_u32 v1, v1, v3
    s_nop 1
    v_max_u32_dpp v1, v1, v1 row_shr:1 row_mask:0xf bank_mask:0xf bound_ctrl:0
    s_nop 1
    v_max_u32_dpp v1, v1, v1 row_shr:2 row_mask:0xf bank_mask:0xf bound_ctrl:0
    s_nop 1
    v_max_u32_dpp v1, v1, v1 row_shr:4 row_mask:0xf bank_mask:0xf bound_ctrl:0
    s_nop 1
    v_max_u32_dpp v1, v1, v1 row_shr:8 row_mask:0xf bank_mask:0xf bound_ctrl:0
    s_nop 1
    v_max_u32_dpp v1, v1, v1 row_bcast:15 row_mask:0xa bank_mask:0xf
    s_nop 1
    v_max_u32_dpp v1, v1, v1 row_bcast:31 row_mask:0xc bank_mask:0xf
    s_nop 1
KS_j:
    v_mov_b32 v2, 1
    s_mov_b32 exec_lo, 0
    s_brev_b32 exec_hi, 1
    ds_max_u32 v238, v1 offset:308
    ds_add_u32 v238, v2 offset:304
    s_mov_b64 exec, -1
    s_mov_b32 s28, s16
    s_and_b32 s29, s17, 0xffff
    s_mov_b32 s30, 3200000
    s_mov_b32 s31, 0x00020000
    v_lshrrev_b32 v1, 4, v157
    v_and_b32 v1, 2, v1
    v_xor_b32 v1, v1, v157
    v_and_b32 v1, 3, v1
    v_lshlrev_b32 v1, 4, v1
    v_lshrrev_b32 v2, 2, v157
    v_lshl_or_b32 v151, v2, 8, v1
    v_and_b32 v1, 15, v157
    v_lshrrev_b32 v2, 4, v157
    v_mul_u32_u24 v3, 272, v1
    s_lshr_b32 s84, s56, 2
    s_mul_i32 s85, s84, 8704
    v_lshl_add_u32 v3, v2, 4, v3
    v_add_u32 v136, s85, v3
    s_lshl_b32 s4, s84, 21
    s_lshl_b32 s84, s56, 11
    s_add_u32 s84, s84, 131072
    v_lshrrev_b32 v3, 1, v157
    v_xor_b32 v2, v2, v3
    v_and_b32 v2, 3, v2
    v_lshl_add_u32 v2, v2, 4, s84
    v_lshl_add_u32 v137, v1, 6, v2
    v_and_b32 v2, 12, v1
    v_lshl_add_u32 v2, v2, 2, s84
    v_and_b32 v3, 3, v1
    v_lshl_add_u32 v138, v3, 1, v2
    v_lshl_add_u32 v139, v157, 4, s84
    v_lshrrev_b32 v2, 3, v157
    v_xor_b32 v2, v2, v157
    v_and_b32 v2, 3, v2
    v_lshlrev_b32 v2, 4, v2
    v_lshrrev_b32 v3, 2, v157
    v_lshl_add_u32 v140, v3, 16, v2
    s_lshl_b32 s84, s57, 8
    s_add_u32 s4, s4, s84
    s_lshl_b32 s84, s74, 6
    s_add_u32 s4, s4, s84
    s_add_u32 s5, s4, 1048576
    s_mul_i32 s84, s56, 272
    v_lshl_add_u32 v142, v157, 2, s84
    v_lshlrev_b32 v150, 1, v156
    v_and_b32 v1, 31, v157
    v_lshlrev_b32 v1, 4, v1
    v_lshlrev_b32 v2, 5, v157
    v_and_b32 v2, 0x400, v2
    v_add3_u32 v145, v1, v2, s80
    v_cndmask_b32 v148, 0, 16, s[78:79]
    v_cndmask_b32 v149, 16, 0, s[78:79]
    v_sub_u32 v2, v154, v156
    v_add_u32 v2, 2144, v2
    v_mov_b32 v1, 464
    v_cndmask_b32 v146, v1, v2, s[78:79]
    v_cndmask_b32 v147, v2, v1, s[78:79]
    s_branch KS_xw_
KS_xw:
    s_sleep 1
KS_xw_:
    ds_read_b32 v2, v238 offset:264
    s_waitcnt lgkmcnt(0)
    v_readfirstlane_b32 s85, v2
    s_and_b32 s85, s85, 255
    s_cmp_lt_u32 s85, 4
    s_cbranch_scc1 KS_xw
    ds_read_b128 v[28:31], v252 offset:0
    ds_read_b128 v[32:35], v253 offset:0
    ds_read_b128 v[36:39], v254 offset:0
    ds_read_b128 v[40:43], v255 offset:0
    ds_read_b128 v[44:47], v252 offset:4096
    ds_read_b128 v[48:51], v253 offset:4096
    ds_read_b128 v[52:55], v254 offset:4096
    ds_read_b128 v[56:59], v255 offset:4096
    s_bitcmp1_b32 s57, 1
    s_cselect_b64 s[86:87], -1, 0
    s_lshl_b32 s84, s57, 4
    s_and_b32 s84, s84, 16
    s_waitcnt vmcnt(0)
    s_mov_b64 exec, vcc
KT_f:
    v_cmp_ne_u32 vcc, s72, v231
    s_cbranch_vccz KT_g
    s_mov_b64 exec, vcc
    s_sub_u32 s73, s73, 1
    s_cbranch_scc1 KT_f2
    s_sleep 4
    buffer_load_dwordx4 v[228:231], v114, s[36:39], s77 offen sc1
    s_waitcnt vmcnt(0)
    s_branch KT_f
KT_f2:
    s_mov_b32 s73, 0
    v_mov_b32 v228, 0
    v_mov_b32 v229, 0
    v_mov_b32 v230, 0
KT_g:
    s_mov_b64 exec, -1
    v_cndmask_b32 v1, v228, v229, s[86:87]
    v_cndmask_b32 v2, v229, v230, s[86:87]
    v_alignbit_b32 v1, v2, v1, s84
    v_sub_u32_sdwa v242, v1, v1 dst_sel:DWORD dst_unused:UNUSED_PAD src0_sel:WORD_1 src1_sel:WORD_0
    v_and_b32 v1, 0xffff, v1
    v_lshrrev_b32 v242, 3, v242
    v_lshl_add_u32 v241, v1, 1, v115
    v_mov_b32 v243, v242
    s_nop 1
    v_add_u32_dpp v243, v243, v243 row_shr:1 row_mask:0xf bank_mask:0xf bound_ctrl:0
    s_nop 1
    v_add_u32_dpp v243, v243, v243 row_shr:2 row_mask:0xf bank_mask:0xf bound_ctrl:0
    s_nop 1
    v_add_u32_dpp v243, v243, v243 row_shr:4 row_mask:0xf bank_mask:0xf bound_ctrl:0
    s_nop 1
    v_add_u32_dpp v243, v243, v243 row_shr:8 row_mask:0xf bank_mask:0xf bound_ctrl:0
    s_nop 1
    v_add_u32_dpp v243, v243, v243 row_bcast:15 row_mask:0xa bank_mask:0xf
    s_nop 1
    v_add_u32_dpp v243, v243, v243 row_bcast:31 row_mask:0xc bank_mask:0xf
    s_nop 1
    v_readlane_b32 s71, v243, 63
    v_sub_u32 v243, v243, v242
    v_mov_b32 v2, v242
    v_lshlrev_b32 v1, 4, v243
    s_mov_b32 s77, 0
    s_cmp_gt_u32 s71, 512
    v_sub_u32 v241, v241, v1
    v_lshl_add_u32 v1, v243, 2, s75
    s_cselect_b32 s85, 0, s71
    s_cbranch_scc1 KT_xe
KT_x:
    v_cmpx_lt_i32 vcc, 0, v2
    ds_write_b32 v1, v241 offset:0
    v_cmpx_lt_i32 vcc, 1, v2
    ds_write_b32 v1, v241 offset:4
    v_cmpx_lt_i32 vcc, 2, v2
    ds_write_b32 v1, v241 offset:8
    v_cmpx_lt_i32 vcc, 3, v2
    ds_write_b32 v1, v241 offset:12
    v_cmpx_lt_i32 vcc, 4, v2
    ds_write_b32 v1, v241 offset:16
    v_cmpx_lt_i32 vcc, 5, v2
    ds_write_b32 v1, v241 offset:20
    v_cmpx_lt_i32 vcc, 6, v2
    ds_write_b32 v1, v241 offset:24
    v_cmpx_lt_i32 vcc, 7, v2
    ds_write_b32 v1, v241 offset:28
    v_cmpx_lt_i32 vcc, 8, v2
    ds_write_b32 v1, v241 offset:32
    v_cmpx_lt_i32 vcc, 9, v2
    ds_write_b32 v1, v241 offset:36
    v_cmpx_lt_i32 vcc, 10, v2
    ds_write_b32 v1, v241 offset:40
    v_cmpx_lt_i32 vcc, 11, v2
    ds_write_b32 v1, v241 offset:44
    v_cmpx_lt_i32 vcc, 12, v2
    ds_write_b32 v1, v241 offset:48
    v_cmpx_lt_i32 vcc, 13, v2
    s_cbranch_vccz KT_xz
    ds_write_b32 v1, v241 offset:52
    v_cmpx_lt_i32 vcc, 14, v2
    ds_write_b32 v1, v241 offset:56
    v_cmpx_lt_i32 vcc, 15, v2
    ds_write_b32 v1, v241 offset:60
    v_add_u32 v2, -16, v2
    v_add_u32 v1, 64, v1
    v_cmp_lt_i32 vcc, 0, v2
    s_cmp_lg_u64 vcc, 0
    s_cbranch_scc1 KT_x
KT_xz:
    s_mov_b64 exec, -1
KT_xe:
    v_lshl_add_u32 v1, v157, 2, s75
    ds_read_b32 v251, v1 offset:1792
    ds_read_b32 v250, v1 offset:1536
    ds_read_b32 v249, v1 offset:1280
    ds_read_b32 v248, v1 offset:1024
    ds_read_b32 v247, v1 offset:768
    ds_read_b32 v246, v1 offset:512
    ds_read_b32 v245, v1 offset:256
    ds_read_b32 v244, v1 offset:0
    v_add_u32 v2, s77, v157
    v_lshlrev_b32 v2, 4, v2
    s_movk_i32 s62, 4096
    v_cmp_gt_i32 s[40:41], s85, v157
    s_sub_u32 s85, s85, 64
    v_cmp_gt_i32 s[42:43], s85, v157
    s_sub_u32 s85, s85, 64
    v_cmp_gt_i32 s[44:45], s85, v157
    s_sub_u32 s85, s85, 64
    v_cmp_gt_i32 s[46:47], s85, v157
    s_sub_u32 s85, s85, 64
    v_cmp_gt_i32 s[48:49], s85, v157
    s_sub_u32 s85, s85, 64
    v_cmp_gt_i32 s[50:51], s85, v157
    s_sub_u32 s85, s85, 64
    v_cmp_gt_i32 s[52:53], s85, v157
    s_sub_u32 s85, s85, 64
    v_cmp_gt_i32 s[54:55], s85, v157
    s_sub_u32 s85, s85, 64
    s_waitcnt lgkmcnt(0)
    v_add_u32 v244, v244, v2
    v_add_u32 v245, v245, v2
    v_add_u32 v246, v246, v2
    v_add_u32 v247, v247, v2
    v_add_u32 v248, v248, v2
    v_add_u32 v249, v249, v2
    v_add_u32 v250, v250, v2
    v_add_u32 v251, v251, v2
    v_mov_b32 v1, 1
    s_mov_b64 exec, 1
    ds_add_u32 v238, v1 offset:280
    s_mov_b64 exec, -1
    s_branch KS_rw_
KS_rw:
    s_sleep 1
KS_rw_:
    ds_read_b32 v1, v238 offset:276
    s_waitcnt lgkmcnt(0)
    v_readfirstlane_b32 s85, v1
    s_and_b32 s85, s85, 255
    s_cmp_lt_u32 s85, 4
    s_cbranch_scc1 KS_rw
    s_mov_b64 exec, s[54:55]
    s_cbranch_execz KT_l7
    buffer_load_dwordx4 v[124:127], v251, s[36:39], s62 offen offset:3072 sc1
KT_l7:
    s_mov_b64 exec, s[52:53]
    s_cbranch_execz KT_l6
    buffer_load_dwordx4 v[120:123], v250, s[36:39], s62 offen offset:2048 sc1
KT_l6:
    s_mov_b64 exec, s[50:51]
    s_cbranch_execz KT_l5
    buffer_load_dwordx4 v[116:119], v249, s[36:39], s62 offen offset:1024 sc1
KT_l5:
    s_mov_b64 exec, s[48:49]
    s_cbranch_execz KT_l4
    buffer_load_dwordx4 v[112:115], v248, s[36:39], s62 offen offset:0 sc1
KT_l4:
    s_mov_b64 exec, s[46:47]
    s_cbranch_execz KT_l3
    buffer_load_dwordx4 v[108:111], v247, s[36:39], 0 offen offset:3072 sc1
KT_l3:
    s_mov_b64 exec, s[44:45]
    s_cbranch_execz KT_l2
    buffer_load_dwordx4 v[104:107], v246, s[36:39], 0 offen offset:2048 sc1
KT_l2:
    s_mov_b64 exec, s[42:43]
    s_cbranch_execz KT_l1
    buffer_load_dwordx4 v[100:103], v245, s[36:39], 0 offen offset:1024 sc1
KT_l1:
    s_mov_b64 exec, s[40:41]
    s_cbranch_execz KT_l0
    buffer_load_dwordx4 v[96:99], v244, s[36:39], 0 offen offset:0 sc1
KT_l0:
    s_mov_b64 exec, -1
    s_branch KS_w2_
KS_w2:
    s_sleep 1
KS_w2_:
    ds_read_b32 v1, v238 offset:288
    s_waitcnt lgkmcnt(0)
    v_readfirstlane_b32 s85, v1
    s_and_b32 s85, s85, 255
    s_cmp_lt_u32 s85, 4
    s_cbranch_scc1 KS_w2
    ds_read_b64_tr_b16 v[160:161], v143 offset:32768
    ds_read_b64_tr_b16 v[162:163], v143 offset:33024
    ds_read_b64_tr_b16 v[164:165], v143 offset:34816
    ds_read_b64_tr_b16 v[166:167], v143 offset:35072
    ds_read_b64_tr_b16 v[168:169], v143 offset:36864
    ds_read_b64_tr_b16 v[170:171], v143 offset:37120
    ds_read_b64_tr_b16 v[172:173], v143 offset:38912
    ds_read_b64_tr_b16 v[174:175], v143 offset:39168
    ds_read_b64_tr_b16 v[176:177], v143 offset:32776
    ds_read_b64_tr_b16 v[178:179], v143 offset:33032
    ds_read_b64_tr_b16 v[180:181], v143 offset:34824
    ds_read_b64_tr_b16 v[182:183], v143 offset:35080
    ds_read_b64_tr_b16 v[184:185], v143 offset:36872
    ds_read_b64_tr_b16 v[186:187], v143 offset:37128
    ds_read_b64_tr_b16 v[188:189], v143 offset:38920
    ds_read_b64_tr_b16 v[190:191], v143 offset:39176
    s_waitcnt lgkmcnt(0)
    v_lshlrev_b32 v1, 3, v157
    ds_read_b64 v[12:13], v1 offset:31744
    ds_read_b64 v[18:19], v1 offset:32256
    ds_read_b64 v[20:21], v1 offset:32768
    ds_read_b64 v[26:27], v1 offset:33280
    v_mfma_f32_16x16x32_bf16 v[208:211], v[160:163], v[28:31], 0
    v_mfma_f32_16x16x32_bf16 v[208:211], v[164:167], v[32:35], v[208:211]
    v_mfma_f32_16x16x32_bf16 v[208:211], v[168:171], v[36:39], v[208:211]
    v_mfma_f32_16x16x32_bf16 v[208:211], v[172:175], v[40:43], v[208:211]
    v_mfma_f32_16x16x32_bf16 v[212:215], v[176:179], v[28:31], 0
    v_mfma_f32_16x16x32_bf16 v[212:215], v[180:183], v[32:35], v[212:215]
    v_mfma_f32_16x16x32_bf16 v[212:215], v[184:187], v[36:39], v[212:215]
    v_mfma_f32_16x16x32_bf16 v[212:215], v[188:191], v[40:43], v[212:215]
    v_mfma_f32_16x16x32_bf16 v[216:219], v[160:163], v[44:47], 0
    v_mfma_f32_16x16x32_bf16 v[216:219], v[164:167], v[48:51], v[216:219]
    v_mfma_f32_16x16x32_bf16 v[216:219], v[168:171], v[52:55], v[216:219]
    v_mfma_f32_16x16x32_bf16 v[216:219], v[172:175], v[56:59], v[216:219]
    v_mfma_f32_16x16x32_bf16 v[220:223], v[176:179], v[44:47], 0
    v_mfma_f32_16x16x32_bf16 v[220:223], v[180:183], v[48:51], v[220:223]
    v_mfma_f32_16x16x32_bf16 v[220:223], v[184:187], v[52:55], v[220:223]
    v_mfma_f32_16x16x32_bf16 v[220:223], v[188:191], v[56:59], v[220:223]
    s_nop 4
    v_pk_mul_f32 v[208:209], v[208:209], s[66:67]
    v_pk_mul_f32 v[210:211], v[210:211], s[66:67]
    v_pk_mul_f32 v[212:213], v[212:213], s[66:67]
    v_pk_mul_f32 v[214:215], v[214:215], s[66:67]
    v_pk_mul_f32 v[216:217], v[216:217], s[66:67]
    v_pk_mul_f32 v[218:219], v[218:219], s[66:67]
    v_pk_mul_f32 v[220:221], v[220:221], s[66:67]
    v_pk_mul_f32 v[222:223], v[222:223], s[66:67]
    v_mov_b32 v1, 4
    s_mov_b32 s63, 72976
KT_hp:
    s_mov_b64 exec, s[54:55]
    s_waitcnt vmcnt(7)
    v_cmpx_eq_u32 s[86:87], s72, v127
    v_lshrrev_b32 v127, 17, v126
    ds_add_rtn_u32 v251, v127, v1
    s_andn2_b64 s[54:55], s[54:55], s[86:87]
    s_mov_b64 vcc, s[54:55]
    s_mov_b64 exec, s[52:53]
    s_waitcnt vmcnt(6)
    v_cmpx_eq_u32 s[84:85], s72, v123
    v_lshrrev_b32 v123, 17, v122
    ds_add_rtn_u32 v250, v123, v1
    s_andn2_b64 s[52:53], s[52:53], s[84:85]
    s_or_b64 vcc, vcc, s[52:53]
    s_mov_b64 exec, s[86:87]
    s_waitcnt lgkmcnt(1)
    v_min_u32 v251, 12540, v251
    v_lshl_add_u32 v127, v251, 1, s63
    ds_write_b32 v251, v126 offset:60416
    ds_write_b64 v127, v[124:125]
    s_mov_b64 exec, s[50:51]
    s_waitcnt vmcnt(5)
    v_cmpx_eq_u32 s[86:87], s72, v119
    v_lshrrev_b32 v119, 17, v118
    ds_add_rtn_u32 v249, v119, v1
    s_andn2_b64 s[50:51], s[50:51], s[86:87]
    s_or_b64 vcc, vcc, s[50:51]
    s_mov_b64 exec, s[84:85]
    s_waitcnt lgkmcnt(3)
    v_min_u32 v250, 12540, v250
    v_lshl_add_u32 v123, v250, 1, s63
    ds_write_b32 v250, v122 offset:60416
    ds_write_b64 v123, v[120:121]
    s_mov_b64 exec, s[48:49]
    s_waitcnt vmcnt(4)
    v_cmpx_eq_u32 s[84:85], s72, v115
    v_lshrrev_b32 v115, 17, v114
    ds_add_rtn_u32 v248, v115, v1
    s_andn2_b64 s[48:49], s[48:49], s[84:85]
    s_or_b64 vcc, vcc, s[48:49]
    s_mov_b64 exec, s[86:87]
    s_waitcnt lgkmcnt(3)
    v_min_u32 v249, 12540, v249
    v_lshl_add_u32 v119, v249, 1, s63
    ds_write_b32 v249, v118 offset:60416
    ds_write_b64 v119, v[116:117]
    s_mov_b64 exec, s[46:47]
    s_waitcnt vmcnt(3)
    v_cmpx_eq_u32 s[86:87], s72, v111
    v_lshrrev_b32 v111, 17, v110
    ds_add_rtn_u32 v247, v111, v1
    s_andn2_b64 s[46:47], s[46:47], s[86:87]
    s_or_b64 vcc, vcc, s[46:47]
    s_mov_b64 exec, s[84:85]
    s_waitcnt lgkmcnt(3)
    v_min_u32 v248, 12540, v248
    v_lshl_add_u32 v115, v248, 1, s63
    ds_write_b32 v248, v114 offset:60416
    ds_write_b64 v115, v[112:113]
    s_mov_b64 exec, s[44:45]
    s_waitcnt vmcnt(2)
    v_cmpx_eq_u32 s[84:85], s72, v107
    v_lshrrev_b32 v107, 17, v106
    ds_add_rtn_u32 v246, v107, v1
    s_andn2_b64 s[44:45], s[44:45], s[84:85]
    s_or_b64 vcc, vcc, s[44:45]
    s_mov_b64 exec, s[86:87]
    s_waitcnt lgkmcnt(3)
    v_min_u32 v247, 12540, v247
    v_lshl_add_u32 v111, v247, 1, s63
    ds_write_b32 v247, v110 offset:60416
    ds_write_b64 v111, v[108:109]
    s_mov_b64 exec, s[42:43]
    s_waitcnt vmcnt(1)
    v_cmpx_eq_u32 s[86:87], s72, v103
    v_lshrrev_b32 v103, 17, v102
    ds_add_rtn_u32 v245, v103, v1
    s_andn2_b64 s[42:43], s[42:43], s[86:87]
    s_or_b64 vcc, vcc, s[42:43]
    s_mov_b64 exec, s[84:85]
    s_waitcnt lgkmcnt(3)
    v_min_u32 v246, 12540, v246
    v_lshl_add_u32 v107, v246, 1, s63
    ds_write_b32 v246, v106 offset:60416
    ds_write_b64 v107, v[104:105]
    s_mov_b64 exec, s[40:41]
    s_waitcnt vmcnt(0)
    v_cmpx_eq_u32 s[84:85], s72, v99
    v_lshrrev_b32 v99, 17, v98
    ds_add_rtn_u32 v244, v99, v1
    s_andn2_b64 s[40:41], s[40:41], s[84:85]
    s_or_b64 vcc, vcc, s[40:41]
    s_cselect_b64 exec, 0, 1
    ds_add_u32 v238, v1 offset:292
    s_mov_b64 exec, s[86:87]
    s_waitcnt lgkmcnt(4)
    v_min_u32 v245, 12540, v245
    v_lshl_add_u32 v103, v245, 1, s63
    ds_write_b32 v245, v102 offset:60416
    ds_write_b64 v103, v[100:101]
    s_mov_b64 exec, s[84:85]
    s_waitcnt lgkmcnt(3)
    v_min_u32 v244, 12540, v244
    v_lshl_add_u32 v99, v244, 1, s63
    ds_write_b32 v244, v98 offset:60416
    ds_write_b64 v99, v[96:97]
    s_cbranch_vccnz KT_hr
KT_hd:
    s_mov_b64 exec, -1
    s_lshr_b32 s85, s2, 3
    s_mul_i32 s85, s85, 391
    v_bfe_u32 v2, v0, 1, 7
    v_add_u32 v2, s85, v2
    v_and_b32 v3, 1, v0
    v_lshlrev_b32 v3, 7, v3
    s_bfm_b64 exec, 16, 0
    buffer_load_dword v239, v[2:3], s[24:27], 0 idxen offen offset:3072 sc1
    s_mov_b64 exec, -1
    s_branch KS_b2_
KS_b2:
    s_sleep 1
KS_b2_:
    ds_read_b32 v1, v238 offset:292
    s_waitcnt lgkmcnt(0)
    v_readfirstlane_b32 s85, v1
    s_and_b32 s85, s85, 255
    s_cmp_lt_u32 s85, 16
    s_cbranch_scc1 KS_b2
    v_lshlrev_b32 v1, 2, v157
    ds_read_b32 v92, v1
    v_cmp_gt_u32 vcc, s58, v157
    v_lshlrev_b32 v93, 8, v157
    s_waitcnt lgkmcnt(0)
    v_sub_u32 v224, v92, v93
    v_add_u32 v3, 12, v224
    v_and_b32 v3, -16, v3
    v_max_u32 v3, 80, v3
    v_cndmask_b32 v3, 0, v3, vcc
    v_mov_b32 v2, v3
    s_nop 1
    v_add_u32_dpp v2, v2, v2 row_shr:1 row_mask:0xf bank_mask:0xf bound_ctrl:0
    s_nop 1
    v_add_u32_dpp v2, v2, v2 row_shr:2 row_mask:0xf bank_mask:0xf bound_ctrl:0
    s_nop 1
    v_add_u32_dpp v2, v2, v2 row_shr:4 row_mask:0xf bank_mask:0xf bound_ctrl:0
    s_nop 1
    v_add_u32_dpp v2, v2, v2 row_shr:8 row_mask:0xf bank_mask:0xf bound_ctrl:0
    s_nop 1
    v_add_u32_dpp v2, v2, v2 row_bcast:15 row_mask:0xa bank_mask:0xf
    s_nop 1
    v_add_u32_dpp v2, v2, v2 row_bcast:31 row_mask:0xc bank_mask:0xf
    s_nop 1
    v_readlane_b32 s84, v2, 63
    v_sub_u32 v2, v2, v3
    v_cmp_lt_u32 vcc, 0x100, v224
    s_add_u32 s60, s84, 127
    s_lshr_b32 s60, s60, 7
    s_cmp_gt_u32 s60, 58
    s_cbranch_scc1 KT_j
    s_cbranch_vccnz KT_j
    s_lshl_b32 s85, s56, 4
    v_add_u32 v225, s85, v2
    v_lshrrev_b32 v225, 3, v225
    v_add_u32 v93, s85, v93
    v_subrev_u32 v226, s85, v3
    v_add_u32 v227, v225, v154
    v_mov_b32 v95, 0x3f80
    ds_write_b32 v1, v2 offset:1872
    v_cmpx_lt_i32 vcc, 0, v226
    ds_write_b16 v225, v93 offset:928
    v_add_u32 v94, 64, v93
    ds_write_b16 v227, v95 offset:2144
    v_cmpx_lt_i32 vcc, 64, v226
    ds_write_b16 v225, v94 offset:936
    v_add_u32 v93, 64, v94
    ds_write_b16 v227, v95 offset:2152
    v_cmpx_lt_i32 vcc, 128, v226
    ds_write_b16 v225, v93 offset:944
    v_add_u32 v94, 64, v93
    ds_write_b16 v227, v95 offset:2160
    v_cmpx_lt_i32 vcc, 192, v226
    ds_write_b16 v225, v94 offset:952
    ds_write_b16 v227, v95 offset:2168
    s_mov_b64 exec, -1
    s_lshl_b32 s85, s56, 2
    v_sub_u32 v226, v3, v224
    v_add_u32 v92, s85, v92
    v_subrev_u32 v226, s85, v226
    s_mov_b32 s85, 72976
    v_mov_b32 v228, 0
    v_mov_b32 v229, 0
    v_mov_b32 v230, 0x200ffff
    v_lshl_add_u32 v231, v92, 1, s85
    v_cmpx_lt_i32 vcc, 0, v226
    ds_write_b32 v92, v230 offset:60416
    ds_write_b64 v231, v[228:229] offset:0
    v_cmpx_lt_i32 vcc, 16, v226
    s_cbranch_vccz KFzp
    ds_write_b32 v92, v230 offset:60432
    ds_write_b64 v231, v[228:229] offset:32
    v_cmpx_lt_i32 vcc, 32, v226
    ds_write_b32 v92, v230 offset:60448
    ds_write_b64 v231, v[228:229] offset:64
    v_cmpx_lt_i32 vcc, 48, v226
    ds_write_b32 v92, v230 offset:60464
    ds_write_b64 v231, v[228:229] offset:96
    v_cmpx_lt_i32 vcc, 64, v226
    ds_write_b32 v92, v230 offset:60480
    ds_write_b64 v231, v[228:229] offset:128
KFzp:
    s_mov_b64 exec, -1
    s_cmp_eq_u32 s56, 3
    s_cbranch_scc0 KFzq
    s_lshr_b32 s85, s84, 3
    v_lshl_add_u32 v225, v157, 1, s85
    v_mov_b32 v226, 12544
    v_add_u32 v227, 12544, v1
    v_lshlrev_b32 v231, 1, v1
    v_add_u32 v231, 98064, v231
    s_mov_b64 exec, 0xff
    ds_write_b16 v225, v226 offset:928
    s_mov_b64 exec, 15
    ds_write_b32 v227, v230 offset:60416
    ds_write_b64 v231, v[228:229]
    s_mov_b64 exec, -1
KFzq:
    v_mov_b32 v1, s60
    ds_write_b32 v238, v1 offset:296
    s_cmp_gt_u32 s71, 512
    s_cbranch_scc0 KT_k
KT_j:
    ds_write_b32 v238, v252 offset:256
KT_k:
    s_mov_b32 s3, 1
    s_lshr_b32 s64, s60, 3
    s_mul_i32 s65, s64, s56
    s_and_b32 s86, s60, 7
    s_min_u32 s87, s86, s56
    s_add_u32 s65, s65, s87
    s_cmp_lt_u32 s56, s86
    s_addc_u32 s64, s64, 0
    s_lshl_b32 s84, s65, 7
    s_lshl_b32 s86, s65, 4
    v_add_u32 v153, s86, v153
    v_add_u32 v152, s86, v152
    s_add_u32 s87, s65, s64
    v_min_u32 v1, 8, v157
    v_sub_u32 v1, s87, v1
    v_lshlrev_b32 v1, 4, v1
    v_max_i32 v1, 0, v1
    s_mov_b32 s32, s14
    s_and_b32 s33, s15, 0xffff
    s_mov_b32 s34, 65536
    s_mov_b32 s35, 0x00020000
    s_setprio 3
    s_waitcnt lgkmcnt(0)
    s_barrier
    s_branch KF_J
KF_T:
    s_load_dword s47, s[18:19], 0
    v_and_b32 v108, 255, v0
    v_mov_b32 v32, 0
    v_mov_b32 v33, 0
    v_mov_b32 v34, 0
    v_mov_b32 v35, 0
    v_lshlrev_b32 v110, 4, v108
    s_mov_b32 s28, s4
    s_and_b32 s29, s5, 0xffff
    s_or_b32 s29, s29, 0x1000000
    s_mov_b32 s30, 12500
    s_mov_b32 s31, 0x00020000
    s_mov_b32 s32, s12
    s_and_b32 s33, s13, 0xffff
    s_mov_b32 s34, 66560
    s_mov_b32 s35, 0x00020000
    v_and_b32 v1, 28, v157
    v_and_b32 v2, 3, v157
    v_lshlrev_b32 v2, 1, v2
    v_lshl_or_b32 v1, v1, 2, v2
    s_lshr_b32 s84, s74, 1
    s_lshl_b32 s84, s84, 7
    s_and_b32 s85, s74, 1
    s_lshl_b32 s85, s85, 3
    s_add_u32 s84, s84, s85
    s_add_u32 s84, s84, 65536
    buffer_load_ushort v124, v1, s[32:35], s84 offen offset:0
    buffer_load_ushort v125, v1, s[32:35], s84 offen offset:256
    buffer_load_ushort v126, v1, s[32:35], s84 offen offset:512
    buffer_load_ushort v127, v1, s[32:35], s84 offen offset:768
    v_lshrrev_b32 v1, 4, v157
    v_and_b32 v1, 2, v1
    v_xor_b32 v1, v1, v157
    v_and_b32 v1, 3, v1
    v_lshlrev_b32 v1, 4, v1
    v_lshrrev_b32 v2, 2, v157
    v_lshl_or_b32 v155, v2, 8, v1
    s_add_u32 m0, s22, 17408
    s_nop 0
    buffer_load_dwordx4 v[36:37], s[28:31], 0 idxen offen lds
    v_add_u32 v36, 4096, v36
    s_add_u32 m0, s22, 21504
    s_nop 0
    buffer_load_dwordx4 v[36:37], s[28:31], 0 idxen offen lds
    v_add_u32 v36, 4096, v36
    s_add_u32 m0, s22, 25600
    s_nop 0
    buffer_load_dwordx4 v[36:37], s[28:31], 0 idxen offen lds
    v_add_u32 v36, 4096, v36
    s_cmp_eq_u32 s56, 4
    s_cbranch_scc0 KT_c
    s_add_u32 m0, s22, 29696
    s_nop 0
    buffer_load_dwordx4 v[36:37], s[28:31], 0 idxen offen lds
    v_add_u32 v36, 4096, v36
KT_c:
    v_cmp_le_u32 vcc, 32, v108
    s_mov_b64 exec, vcc
    ds_write_b128 v110, v[32:35]
    s_mov_b64 exec, -1
    ds_write_b128 v110, v[32:35] offset:4096
    ds_write_b128 v110, v[32:35] offset:8192
    ds_write_b128 v110, v[32:35] offset:12288
    s_cmp_eq_u32 s56, 4
    s_cbranch_scc0 KT_b
    ds_write_b128 v110, v[32:35] offset:16384
KT_b:
    s_lshl_b32 s84, s74, 2
    v_lshrrev_b32 v2, 4, v157
    v_or_b32 v1, s84, v2
    v_xor_b32 v3, v1, v158
    v_lshlrev_b32 v3, 4, v3
    v_lshl_add_u32 v116, v158, 8, v3
    v_add_u32 v116, 62464, v116
    v_add_u32 v117, 62464, v110
    v_lshl_add_u32 v118, v1, 16, v3
    s_lshl_b32 s84, s74, 6
    s_add_u32 m0, s61, 0
    s_add_u32 s85, s84, 0
    buffer_load_dwordx4 v155, s[32:35], s85 offen lds
    s_add_u32 m0, s61, 1024
    s_add_u32 s85, s84, 4096
    buffer_load_dwordx4 v155, s[32:35], s85 offen lds
    s_branch KG_tw_
KG_tw:
    s_sleep 1
KG_tw_:
    ds_read_b32 v1, v238 offset:316
    s_waitcnt lgkmcnt(0)
    v_readfirstlane_b32 s85, v1
    s_and_b32 s85, s85, 255
    s_cmp_lt_u32 s85, 4
    s_cbranch_scc1 KG_tw
    s_lshl_b32 s84, s74, 6
    s_add_u32 m0, s61, 2048
    s_add_u32 s85, s84, 8192
    buffer_load_dwordx4 v155, s[32:35], s85 offen lds
    s_add_u32 m0, s61, 3072
    s_add_u32 s85, s84, 12288
    buffer_load_dwordx4 v155, s[32:35], s85 offen lds
    s_add_u32 m0, s61, 4096
    s_add_u32 s85, s84, 16384
    buffer_load_dwordx4 v155, s[32:35], s85 offen lds
    s_add_u32 m0, s61, 5120
    s_add_u32 s85, s84, 20480
    buffer_load_dwordx4 v155, s[32:35], s85 offen lds
    s_add_u32 m0, s61, 6144
    s_add_u32 s85, s84, 24576
    buffer_load_dwordx4 v155, s[32:35], s85 offen lds
    s_add_u32 m0, s61, 7168
    s_add_u32 s85, s84, 28672
    buffer_load_dwordx4 v155, s[32:35], s85 offen lds
    s_lshl_b32 s84, s74, 6
    s_add_u32 m0, s61, -32768
    s_add_u32 s85, s84, 32768
    buffer_load_dwordx4 v155, s[32:35], s85 offen lds
    s_add_u32 m0, s61, -31744
    s_add_u32 s85, s84, 36864
    buffer_load_dwordx4 v155, s[32:35], s85 offen lds
    s_add_u32 m0, s61, -30720
    s_add_u32 s85, s84, 40960
    buffer_load_dwordx4 v155, s[32:35], s85 offen lds
    s_add_u32 m0, s61, -29696
    s_add_u32 s85, s84, 45056
    buffer_load_dwordx4 v155, s[32:35], s85 offen lds
    s_add_u32 m0, s61, -28672
    s_add_u32 s85, s84, 49152
    buffer_load_dwordx4 v155, s[32:35], s85 offen lds
    s_add_u32 m0, s61, -27648
    s_add_u32 s85, s84, 53248
    buffer_load_dwordx4 v155, s[32:35], s85 offen lds
    s_add_u32 m0, s61, -26624
    s_add_u32 s85, s84, 57344
    buffer_load_dwordx4 v155, s[32:35], s85 offen lds
    s_add_u32 m0, s61, -25600
    s_add_u32 s85, s84, 61440
    buffer_load_dwordx4 v155, s[32:35], s85 offen lds
    v_mov_b32 v1, 1
    s_mov_b64 exec, 1
    ds_add_u32 v238, v1 offset:300
    s_mov_b64 exec, -1
    v_mov_b32 v1, 0x3f803f80
    ds_write2_b32 v238, v1, v1 offset0:100 offset1:103
    s_waitcnt vmcnt(16)
    v_mov_b32 v2, 1
    s_mov_b64 exec, 1
    ds_add_u32 v238, v2 offset:264
    s_mov_b64 exec, -1
KG_y1:
    ds_read_b32 v2, v238 offset:264
    s_waitcnt lgkmcnt(0)
    v_readfirstlane_b32 s85, v2
    s_and_b32 s85, s85, 255
    s_cmp_lt_u32 s85, 4
    s_cbranch_scc1 KG_y1
    s_setprio 1
    ds_read_b128 v[28:31], v252 offset:0
    ds_read_b128 v[32:35], v253 offset:0
    ds_read_b128 v[36:39], v254 offset:0
    ds_read_b128 v[40:43], v255 offset:0
    s_waitcnt vmcnt(8)
    ds_read_b64_tr_b16 v[160:161], v143 offset:32768
    ds_read_b64_tr_b16 v[162:163], v143 offset:33024
    ds_read_b64_tr_b16 v[164:165], v143 offset:34816
    ds_read_b64_tr_b16 v[166:167], v143 offset:35072
    ds_read_b64_tr_b16 v[168:169], v143 offset:36864
    ds_read_b64_tr_b16 v[170:171], v143 offset:37120
    ds_read_b64_tr_b16 v[172:173], v143 offset:38912
    ds_read_b64_tr_b16 v[174:175], v143 offset:39168
    s_waitcnt lgkmcnt(7)
    ds_read_b64_tr_b16 v[176:177], v143 offset:32776
    ds_read_b64_tr_b16 v[178:179], v143 offset:33032
    ds_read_b64_tr_b16 v[180:181], v143 offset:34824
    ds_read_b64_tr_b16 v[182:183], v143 offset:35080
    ds_read_b64_tr_b16 v[184:185], v143 offset:36872
    ds_read_b64_tr_b16 v[186:187], v143 offset:37128
    ds_read_b64_tr_b16 v[188:189], v143 offset:38920
    ds_read_b64_tr_b16 v[190:191], v143 offset:39176
    s_waitcnt lgkmcnt(8)
    ds_read_b128 v[44:47], v252 offset:4096
    ds_read_b128 v[48:51], v253 offset:4096
    ds_read_b128 v[52:55], v254 offset:4096
    ds_read_b128 v[56:59], v255 offset:4096
    v_mfma_f32_16x16x32_bf16 v[192:195], v[160:163], v[28:31], 0
    v_mfma_f32_16x16x32_bf16 v[192:195], v[164:167], v[32:35], v[192:195]
    v_mfma_f32_16x16x32_bf16 v[192:195], v[168:171], v[36:39], v[192:195]
    v_mfma_f32_16x16x32_bf16 v[192:195], v[172:175], v[40:43], v[192:195]
    s_waitcnt lgkmcnt(4)
    ds_read_b128 v[60:63], v252 offset:8192
    ds_read_b128 v[64:67], v253 offset:8192
    ds_read_b128 v[68:71], v254 offset:8192
    ds_read_b128 v[72:75], v255 offset:8192
    ds_read_b128 v[76:79], v252 offset:12288
    ds_read_b128 v[80:83], v253 offset:12288
    ds_read_b128 v[84:87], v254 offset:12288
    ds_read_b128 v[88:91], v255 offset:12288
    v_mfma_f32_16x16x32_bf16 v[196:199], v[176:179], v[28:31], 0
    v_mfma_f32_16x16x32_bf16 v[196:199], v[180:183], v[32:35], v[196:199]
    v_mfma_f32_16x16x32_bf16 v[196:199], v[184:187], v[36:39], v[196:199]
    v_mfma_f32_16x16x32_bf16 v[196:199], v[188:191], v[40:43], v[196:199]
    s_waitcnt lgkmcnt(8)
    v_mfma_f32_16x16x32_bf16 v[200:203], v[160:163], v[44:47], 0
    v_mfma_f32_16x16x32_bf16 v[200:203], v[164:167], v[48:51], v[200:203]
    v_mfma_f32_16x16x32_bf16 v[200:203], v[168:171], v[52:55], v[200:203]
    v_mfma_f32_16x16x32_bf16 v[200:203], v[172:175], v[56:59], v[200:203]
    v_mfma_f32_16x16x32_bf16 v[204:207], v[176:179], v[44:47], 0
    v_mfma_f32_16x16x32_bf16 v[204:207], v[180:183], v[48:51], v[204:207]
    v_mfma_f32_16x16x32_bf16 v[204:207], v[184:187], v[52:55], v[204:207]
    v_mfma_f32_16x16x32_bf16 v[204:207], v[188:191], v[56:59], v[204:207]
    s_waitcnt lgkmcnt(0)
    v_mfma_f32_16x16x32_bf16 v[208:211], v[160:163], v[60:63], 0
    v_mul_f32 v192, s66, v192
    v_mul_f32 v193, s66, v193
    v_mfma_f32_16x16x32_bf16 v[208:211], v[164:167], v[64:67], v[208:211]
    v_mul_f32 v194, s66, v194
    v_mul_f32 v195, s66, v195
    v_mfma_f32_16x16x32_bf16 v[208:211], v[168:171], v[68:71], v[208:211]
    v_mul_f32 v196, s66, v196
    v_mul_f32 v197, s66, v197
    v_mfma_f32_16x16x32_bf16 v[208:211], v[172:175], v[72:75], v[208:211]
    v_mul_f32 v198, s66, v198
    v_mul_f32 v199, s66, v199
    v_mfma_f32_16x16x32_bf16 v[212:215], v[176:179], v[60:63], 0
    v_cvt_pk_bf16_f32 v192, v192, v193
    v_cvt_pk_bf16_f32 v193, v194, v195
    v_mfma_f32_16x16x32_bf16 v[212:215], v[180:183], v[64:67], v[212:215]
    v_cvt_pk_bf16_f32 v194, v196, v197
    v_cvt_pk_bf16_f32 v195, v198, v199
    v_mfma_f32_16x16x32_bf16 v[212:215], v[184:187], v[68:71], v[212:215]
    ds_write_b128 v116, v[192:195] offset:0
    v_mfma_f32_16x16x32_bf16 v[212:215], v[188:191], v[72:75], v[212:215]
    v_mfma_f32_16x16x32_bf16 v[216:219], v[160:163], v[76:79], 0
    v_mul_f32 v200, s66, v200
    v_mul_f32 v201, s66, v201
    v_mfma_f32_16x16x32_bf16 v[216:219], v[164:167], v[80:83], v[216:219]
    v_mul_f32 v202, s66, v202
    v_mul_f32 v203, s66, v203
    v_mfma_f32_16x16x32_bf16 v[216:219], v[168:171], v[84:87], v[216:219]
    v_mul_f32 v204, s66, v204
    v_mul_f32 v205, s66, v205
    v_mfma_f32_16x16x32_bf16 v[216:219], v[172:175], v[88:91], v[216:219]
    v_mul_f32 v206, s66, v206
    v_mul_f32 v207, s66, v207
    v_mfma_f32_16x16x32_bf16 v[220:223], v[176:179], v[76:79], 0
    v_cvt_pk_bf16_f32 v200, v200, v201
    v_cvt_pk_bf16_f32 v201, v202, v203
    v_mfma_f32_16x16x32_bf16 v[220:223], v[180:183], v[80:83], v[220:223]
    v_cvt_pk_bf16_f32 v202, v204, v205
    v_cvt_pk_bf16_f32 v203, v206, v207
    v_mfma_f32_16x16x32_bf16 v[220:223], v[184:187], v[84:87], v[220:223]
    ds_write_b128 v116, v[200:203] offset:4096
    v_mfma_f32_16x16x32_bf16 v[220:223], v[188:191], v[88:91], v[220:223]
    s_lshl_b32 s86, s57, 8
    s_nop 2
    v_mul_f32 v208, s66, v208
    v_mul_f32 v209, s66, v209
    v_mul_f32 v210, s66, v210
    v_mul_f32 v211, s66, v211
    v_mul_f32 v212, s66, v212
    v_mul_f32 v213, s66, v213
    v_mul_f32 v214, s66, v214
    v_mul_f32 v215, s66, v215
    v_cvt_pk_bf16_f32 v208, v208, v209
    v_cvt_pk_bf16_f32 v209, v210, v211
    v_cvt_pk_bf16_f32 v210, v212, v213
    v_cvt_pk_bf16_f32 v211, v214, v215
    ds_write_b128 v116, v[208:211] offset:8192
    v_mul_f32 v216, s66, v216
    v_mul_f32 v217, s66, v217
    v_mul_f32 v218, s66, v218
    v_mul_f32 v219, s66, v219
    v_mul_f32 v220, s66, v220
    v_mul_f32 v221, s66, v221
    v_mul_f32 v222, s66, v222
    v_mul_f32 v223, s66, v223
    v_cvt_pk_bf16_f32 v216, v216, v217
    v_cvt_pk_bf16_f32 v217, v218, v219
    v_cvt_pk_bf16_f32 v218, v220, v221
    v_cvt_pk_bf16_f32 v219, v222, v223
    ds_write_b128 v116, v[216:219] offset:12288
    v_mov_b32 v2, 1
    s_mov_b64 exec, 1
    ds_add_u32 v238, v2 offset:268
    s_mov_b64 exec, -1
KG_y2:
    ds_read_b32 v2, v238 offset:268
    s_waitcnt lgkmcnt(0)
    v_readfirstlane_b32 s85, v2
    s_and_b32 s85, s85, 255
    s_cmp_lt_u32 s85, 4
    s_cbranch_scc1 KG_y2
    ds_read_b128 v[92:95], v117 offset:0
    ds_read_b128 v[96:99], v117 offset:4096
    ds_read_b128 v[100:103], v117 offset:8192
    ds_read_b128 v[104:107], v117 offset:12288
KG_n:
    ds_read_b32 v1, v238 offset:312
    s_waitcnt vmcnt(0) lgkmcnt(0)
    v_readfirstlane_b32 s72, v1
    s_cmp_eq_u32 s72, 0
    s_cbranch_scc1 KG_n
    s_mul_i32 s23, s72, 0x9E3779B1
    s_mul_i32 s59, s23, 0x85EBCA6B
    s_mul_hi_u32 s23, s23, 65
    s_mul_hi_u32 s59, s59, 8
    s_mul_i32 s23, s23, 3276800
    s_mul_i32 s59, s59, 6881280
    s_add_u32 s24, s24, s23
    s_addc_u32 s25, s25, 0
    s_add_u32 s86, s86, s23
    s_add_u32 s85, s86, 55054336
    buffer_store_dwordx4 v[92:95], v118, s[36:39], s85 offen sc1
    s_add_u32 s85, s86, 56102912
    buffer_store_dwordx4 v[96:99], v118, s[36:39], s85 offen sc1
    s_add_u32 s85, s86, 57151488
    buffer_store_dwordx4 v[100:103], v118, s[36:39], s85 offen sc1
    s_cmp_eq_u32 s56, 4
    s_cbranch_scc0 KG_p
    s_add_u32 s85, s86, 58200064
    s_waitcnt lgkmcnt(0)
    s_mov_b64 exec, 0xffff
    buffer_store_dwordx4 v[104:107], v118, s[36:39], s85 offen sc1
    s_mov_b64 exec, -1
KG_p:
    s_setprio 0
    s_mov_b32 s32, s14
    s_and_b32 s33, s15, 0xffff
    s_mov_b32 s34, 65536
    s_mov_b32 s35, 0x00020000
    v_lshlrev_b32 v124, 16, v124
    v_mul_f32 v124, s66, v124
    v_lshlrev_b32 v125, 16, v125
    v_mul_f32 v125, s66, v125
    v_lshlrev_b32 v126, 16, v126
    v_mul_f32 v126, s66, v126
    v_lshlrev_b32 v127, 16, v127
    v_mul_f32 v127, s66, v127
    v_cvt_pk_bf16_f32 v224, v124, v125
    v_cvt_pk_bf16_f32 v225, v126, v127
    v_lshlrev_b32 v226, 16, v224
    v_and_b32 v227, 0xffff0000, v224
    v_lshlrev_b32 v228, 16, v225
    v_and_b32 v229, 0xffff0000, v225
    v_add_f32 v230, abs(v124), abs(v125)
    v_sub_f32 v226, v124, v226
    v_sub_f32 v227, v125, v227
    v_sub_f32 v228, v126, v228
    v_sub_f32 v229, v127, v229
    v_add_f32 v231, abs(v126), abs(v127)
    s_mov_b32 exec_lo, 0
    v_cvt_pk_bf16_f32 v224, v226, v227
    v_cvt_pk_bf16_f32 v225, v228, v229
    s_mov_b32 exec_lo, -1
    v_add_f32 v230, v230, v231
    v_lshlrev_b32 v1, 3, v108
    v_and_b32 v230, 0x7fffffff, v230
    ds_write_b64 v1, v[224:225] offset:31744
    s_nop 1
    v_max_u32_dpp v230, v230, v230 row_shr:1 row_mask:0xf bank_mask:0xf bound_ctrl:0
    s_nop 1
    v_max_u32_dpp v230, v230, v230 row_shr:2 row_mask:0xf bank_mask:0xf bound_ctrl:0
    s_nop 1
    v_max_u32_dpp v230, v230, v230 row_shr:4 row_mask:0xf bank_mask:0xf bound_ctrl:0
    s_nop 1
    v_max_u32_dpp v230, v230, v230 row_shr:8 row_mask:0xf bank_mask:0xf bound_ctrl:0
    s_nop 1
    v_max_u32_dpp v230, v230, v230 row_bcast:15 row_mask:0xa bank_mask:0xf
    s_nop 1
    v_max_u32_dpp v230, v230, v230 row_bcast:31 row_mask:0xc bank_mask:0xf
    s_nop 1
    s_mov_b32 exec_lo, 0
    s_brev_b32 exec_hi, 1
    ds_max_u32 v238, v230 offset:272
    s_mov_b64 exec, -1
    v_pk_maximum3_f16 v114, v192, v193, v194
    v_pk_minimum3_f16 v115, v192, v193, v194
    v_pk_maximum3_f16 v114, v114, v195, v195
    v_pk_minimum3_f16 v115, v115, v195, v195
    v_pk_maximum3_f16 v114, v114, v200, v201
    v_pk_minimum3_f16 v115, v115, v200, v201
    v_pk_maximum3_f16 v114, v114, v202, v203
    v_pk_minimum3_f16 v115, v115, v202, v203
    v_pk_maximum3_f16 v114, v114, v208, v209
    v_pk_minimum3_f16 v115, v115, v208, v209
    v_pk_maximum3_f16 v114, v114, v210, v211
    v_pk_minimum3_f16 v115, v115, v210, v211
    s_mov_b32 exec_lo, 0x10001
    s_mov_b32 exec_hi, 0x10001
    v_pk_maximum3_f16 v114, v114, v216, v217
    v_pk_minimum3_f16 v115, v115, v216, v217
    v_pk_maximum3_f16 v114, v114, v218, v219
    v_pk_minimum3_f16 v115, v115, v218, v219
    s_mov_b64 exec, -1
    v_and_b32 v114, 0x7fff7fff, v114
    v_and_b32 v115, 0x7fff7fff, v115
    v_pk_max_u16 v114, v114, v115
    v_lshlrev_b32 v2, 16, v114
    v_and_b32 v114, 0xffff0000, v114
    v_max_u32 v114, v114, v2
    v_cmp_lt_u32 vcc, 0x40e80000, v114
    s_cmp_lg_u64 vcc, 0
    s_cselect_b32 s76, 0x101, 1
    v_xor_b32 v242, 32, v240
    ds_read_b64_tr_b16 v[160:161], v242 offset:0
    ds_read_b64_tr_b16 v[162:163], v242 offset:256
    ds_read_b64_tr_b16 v[164:165], v242 offset:2048
    ds_read_b64_tr_b16 v[166:167], v242 offset:2304
    ds_read_b64_tr_b16 v[168:169], v242 offset:4096
    ds_read_b64_tr_b16 v[170:171], v242 offset:4352
    ds_read_b64_tr_b16 v[172:173], v242 offset:6144
    ds_read_b64_tr_b16 v[174:175], v242 offset:6400
    s_lshl_b32 s84, s74, 8
    s_add_u32 s84, s84, 33792
    v_lshrrev_b32 v1, 4, v157
    v_lshl_add_u32 v120, v1, 11, s84
    v_and_b32 v1, 8, v157
    v_lshl_add_u32 v120, v1, 3, v120
    v_and_b32 v1, 3, v157
    v_lshl_add_u32 v120, v1, 4, v120
    v_and_b32 v1, 4, v157
    v_lshl_add_u32 v120, v1, 1, v120
    v_add_u32 v121, 128, v120
    s_waitcnt lgkmcnt(0)
    ds_read_b64_tr_b16 v[176:177], v240 offset:0
    ds_read_b64_tr_b16 v[178:179], v240 offset:256
    ds_read_b64_tr_b16 v[180:181], v240 offset:2048
    ds_read_b64_tr_b16 v[182:183], v240 offset:2304
    ds_read_b64_tr_b16 v[184:185], v240 offset:4096
    ds_read_b64_tr_b16 v[186:187], v240 offset:4352
    ds_read_b64_tr_b16 v[188:189], v240 offset:6144
    ds_read_b64_tr_b16 v[190:191], v240 offset:6400
    v_mfma_f32_16x16x32_bf16 v[192:195], v[28:31], v[160:163], 0
    v_mfma_f32_16x16x32_bf16 v[192:195], v[32:35], v[164:167], v[192:195]
    v_mfma_f32_16x16x32_bf16 v[192:195], v[36:39], v[168:171], v[192:195]
    v_mfma_f32_16x16x32_bf16 v[192:195], v[40:43], v[172:175], v[192:195]
    v_mfma_f32_16x16x32_bf16 v[196:199], v[44:47], v[160:163], 0
    v_mfma_f32_16x16x32_bf16 v[196:199], v[48:51], v[164:167], v[196:199]
    v_mfma_f32_16x16x32_bf16 v[196:199], v[52:55], v[168:171], v[196:199]
    v_mfma_f32_16x16x32_bf16 v[196:199], v[56:59], v[172:175], v[196:199]
    v_mfma_f32_16x16x32_bf16 v[200:203], v[60:63], v[160:163], 0
    v_mfma_f32_16x16x32_bf16 v[200:203], v[64:67], v[164:167], v[200:203]
    v_mfma_f32_16x16x32_bf16 v[200:203], v[68:71], v[168:171], v[200:203]
    v_mfma_f32_16x16x32_bf16 v[200:203], v[72:75], v[172:175], v[200:203]
    v_mfma_f32_16x16x32_bf16 v[204:207], v[76:79], v[160:163], 0
    v_mfma_f32_16x16x32_bf16 v[204:207], v[80:83], v[164:167], v[204:207]
    v_mfma_f32_16x16x32_bf16 v[204:207], v[84:87], v[168:171], v[204:207]
    v_mfma_f32_16x16x32_bf16 v[204:207], v[88:91], v[172:175], v[204:207]
    s_waitcnt lgkmcnt(0)
    v_mfma_f32_16x16x32_bf16 v[208:211], v[28:31], v[176:179], 0
    v_mul_f32 v192, s66, v192
    v_mul_f32 v193, s66, v193
    v_mfma_f32_16x16x32_bf16 v[208:211], v[32:35], v[180:183], v[208:211]
    v_mul_f32 v194, s66, v194
    v_mul_f32 v195, s66, v195
    v_mfma_f32_16x16x32_bf16 v[208:211], v[36:39], v[184:187], v[208:211]
    v_and_b32 v228, 0xffff0000, v192
    v_and_b32 v229, 0xffff0000, v193
    v_mfma_f32_16x16x32_bf16 v[208:211], v[40:43], v[188:191], v[208:211]
    v_and_b32 v230, 0xffff0000, v194
    v_and_b32 v231, 0xffff0000, v195
    v_mfma_f32_16x16x32_bf16 v[212:215], v[44:47], v[176:179], 0
    v_maximum3_f32 v225, 0, abs(v192), abs(v193)
    v_maximum3_f32 v225, v225, abs(v194), abs(v195)
    v_mfma_f32_16x16x32_bf16 v[212:215], v[48:51], v[180:183], v[212:215]
    v_sub_f32 v192, v192, v228
    v_sub_f32 v193, v193, v229
    v_mfma_f32_16x16x32_bf16 v[212:215], v[52:55], v[184:187], v[212:215]
    v_sub_f32 v194, v194, v230
    v_sub_f32 v195, v195, v231
    v_mfma_f32_16x16x32_bf16 v[212:215], v[56:59], v[188:191], v[212:215]
    v_cvt_pk_bf16_f32 v192, v192, v228
    v_cvt_pk_bf16_f32 v193, v193, v229
    v_mfma_f32_16x16x32_bf16 v[216:219], v[60:63], v[176:179], 0
    v_cvt_pk_bf16_f32 v194, v194, v230
    v_cvt_pk_bf16_f32 v195, v195, v231
    v_mfma_f32_16x16x32_bf16 v[216:219], v[64:67], v[180:183], v[216:219]
    v_mul_f32 v196, s66, v196
    v_mul_f32 v197, s66, v197
    v_mfma_f32_16x16x32_bf16 v[216:219], v[68:71], v[184:187], v[216:219]
    v_mul_f32 v198, s66, v198
    v_mul_f32 v199, s66, v199
    v_mfma_f32_16x16x32_bf16 v[216:219], v[72:75], v[188:191], v[216:219]
    v_and_b32 v228, 0xffff0000, v196
    v_and_b32 v229, 0xffff0000, v197
    v_mfma_f32_16x16x32_bf16 v[220:223], v[76:79], v[176:179], 0
    v_and_b32 v230, 0xffff0000, v198
    v_and_b32 v231, 0xffff0000, v199
    v_mfma_f32_16x16x32_bf16 v[220:223], v[80:83], v[180:183], v[220:223]
    v_maximum3_f32 v225, v225, abs(v196), abs(v197)
    v_maximum3_f32 v225, v225, abs(v198), abs(v199)
    v_mfma_f32_16x16x32_bf16 v[220:223], v[84:87], v[184:187], v[220:223]
    v_sub_f32 v196, v196, v228
    v_sub_f32 v197, v197, v229
    v_mfma_f32_16x16x32_bf16 v[220:223], v[88:91], v[188:191], v[220:223]
    v_sub_f32 v198, v198, v230
    v_sub_f32 v199, v199, v231
    s_lshl_b32 s84, s74, 6
    s_add_u32 m0, s61, 0
    s_add_u32 s85, s84, 0
    buffer_load_dwordx4 v155, s[32:35], s85 offen lds
    s_add_u32 m0, s61, 1024
    s_add_u32 s85, s84, 4096
    buffer_load_dwordx4 v155, s[32:35], s85 offen lds
    s_add_u32 m0, s61, 2048
    s_add_u32 s85, s84, 8192
    buffer_load_dwordx4 v155, s[32:35], s85 offen lds
    s_add_u32 m0, s61, 3072
    s_add_u32 s85, s84, 12288
    buffer_load_dwordx4 v155, s[32:35], s85 offen lds
    s_add_u32 m0, s61, 4096
    s_add_u32 s85, s84, 16384
    buffer_load_dwordx4 v155, s[32:35], s85 offen lds
    s_add_u32 m0, s61, 5120
    s_add_u32 s85, s84, 20480
    buffer_load_dwordx4 v155, s[32:35], s85 offen lds
    s_add_u32 m0, s61, 6144
    s_add_u32 s85, s84, 24576
    buffer_load_dwordx4 v155, s[32:35], s85 offen lds
    s_add_u32 m0, s61, 7168
    s_add_u32 s85, s84, 28672
    buffer_load_dwordx4 v155, s[32:35], s85 offen lds
    s_lshl_b32 s86, s2, 2
    s_add_u32 s86, s86, 58269696
    s_add_u32 s86, s86, s23
    v_mov_b32 v1, s76
    s_waitcnt vmcnt(8)
    s_mov_b64 exec, 1
    ds_add_rtn_u32 v1, v238, v1 offset:276
    s_waitcnt lgkmcnt(0)
    v_readfirstlane_b32 s85, v1
    s_add_u32 s85, s85, s76
    s_and_b32 s84, s85, 255
    s_cmp_eq_u32 s84, 4
    s_cbranch_scc0 KG_f
KG_e:
    ds_read_b64 v[2:3], v238 offset:304
    ds_read_b32 v1, v238 offset:272
    s_waitcnt lgkmcnt(0)
    v_cmp_gt_u32 vcc, 4, v2
    v_mul_f32 v1, v1, v3
    s_cbranch_vccnz KG_e
    v_cmp_nge_f32 vcc, 0x41680000, v1
    s_lshl_b32 s84, vcc_lo, 8
    s_or_b32 s85, s85, s84
    s_cmp_gt_u32 s85, 255
    s_cselect_b32 s84, 2, 0
    s_xor_b32 s84, s72, s84
    s_mov_b64 exec, 255
    v_mov_b32 v1, s84
    v_lshlrev_b32 v2, 10, v157
    buffer_store_dword v1, v2, s[36:39], s86 offen sc1
    s_waitcnt vmcnt(1)
    s_branch KG_f2
KG_f:
    s_waitcnt vmcnt(0)
KG_f2:
    s_mov_b64 exec, -1
    v_mov_b32 v1, 1
    s_mov_b64 exec, 1
    ds_add_u32 v238, v1 offset:288
    s_mov_b64 exec, -1
    v_cvt_pk_bf16_f32 v196, v196, v228
    v_cvt_pk_bf16_f32 v197, v197, v229
    v_cvt_pk_bf16_f32 v198, v198, v230
    v_cvt_pk_bf16_f32 v199, v199, v231
    v_pk_mul_f32 v[200:201], v[200:201], s[66:67]
    v_pk_mul_f32 v[202:203], v[202:203], s[66:67]
    v_and_b32 v228, 0xffff0000, v200
    v_and_b32 v229, 0xffff0000, v201
    v_and_b32 v230, 0xffff0000, v202
    v_and_b32 v231, 0xffff0000, v203
    v_maximum3_f32 v225, v225, abs(v200), abs(v201)
    v_maximum3_f32 v225, v225, abs(v202), abs(v203)
    v_pk_add_f32 v[200:201], v[200:201], v[228:229] neg_lo:[0,1] neg_hi:[0,1]
    v_pk_add_f32 v[202:203], v[202:203], v[230:231] neg_lo:[0,1] neg_hi:[0,1]
    v_cvt_pk_bf16_f32 v200, v200, v228
    v_cvt_pk_bf16_f32 v201, v201, v229
    v_cvt_pk_bf16_f32 v202, v202, v230
    v_cvt_pk_bf16_f32 v203, v203, v231
    v_pk_mul_f32 v[208:209], v[208:209], s[66:67]
    v_pk_mul_f32 v[210:211], v[210:211], s[66:67]
    v_and_b32 v228, 0xffff0000, v208
    v_and_b32 v229, 0xffff0000, v209
    v_and_b32 v230, 0xffff0000, v210
    v_and_b32 v231, 0xffff0000, v211
    v_maximum3_f32 v225, v225, abs(v208), abs(v209)
    v_maximum3_f32 v225, v225, abs(v210), abs(v211)
    v_pk_add_f32 v[208:209], v[208:209], v[228:229] neg_lo:[0,1] neg_hi:[0,1]
    v_pk_add_f32 v[210:211], v[210:211], v[230:231] neg_lo:[0,1] neg_hi:[0,1]
    v_cvt_pk_bf16_f32 v208, v208, v228
    v_cvt_pk_bf16_f32 v209, v209, v229
    v_cvt_pk_bf16_f32 v210, v210, v230
    v_cvt_pk_bf16_f32 v211, v211, v231
    v_pk_mul_f32 v[212:213], v[212:213], s[66:67]
    v_pk_mul_f32 v[214:215], v[214:215], s[66:67]
    v_and_b32 v228, 0xffff0000, v212
    v_and_b32 v229, 0xffff0000, v213
    v_and_b32 v230, 0xffff0000, v214
    v_and_b32 v231, 0xffff0000, v215
    v_maximum3_f32 v225, v225, abs(v212), abs(v213)
    v_maximum3_f32 v225, v225, abs(v214), abs(v215)
    v_pk_add_f32 v[212:213], v[212:213], v[228:229] neg_lo:[0,1] neg_hi:[0,1]
    v_pk_add_f32 v[214:215], v[214:215], v[230:231] neg_lo:[0,1] neg_hi:[0,1]
    v_cvt_pk_bf16_f32 v212, v212, v228
    v_cvt_pk_bf16_f32 v213, v213, v229
    v_cvt_pk_bf16_f32 v214, v214, v230
    v_cvt_pk_bf16_f32 v215, v215, v231
    v_pk_mul_f32 v[216:217], v[216:217], s[66:67]
    v_pk_mul_f32 v[218:219], v[218:219], s[66:67]
    v_and_b32 v228, 0xffff0000, v216
    v_and_b32 v229, 0xffff0000, v217
    v_and_b32 v230, 0xffff0000, v218
    v_and_b32 v231, 0xffff0000, v219
    v_maximum3_f32 v225, v225, abs(v216), abs(v217)
    v_maximum3_f32 v225, v225, abs(v218), abs(v219)
    v_pk_add_f32 v[216:217], v[216:217], v[228:229] neg_lo:[0,1] neg_hi:[0,1]
    v_pk_add_f32 v[218:219], v[218:219], v[230:231] neg_lo:[0,1] neg_hi:[0,1]
    v_cvt_pk_bf16_f32 v216, v216, v228
    v_cvt_pk_bf16_f32 v217, v217, v229
    v_cvt_pk_bf16_f32 v218, v218, v230
    v_cvt_pk_bf16_f32 v219, v219, v231
    s_branch KGqw_
KGqw:
    s_sleep 1
KGqw_:
    ds_read_b32 v1, v238 offset:280
    s_waitcnt lgkmcnt(0)
    v_readfirstlane_b32 s85, v1
    s_and_b32 s85, s85, 255
    s_cmp_lt_u32 s85, 4
    s_cbranch_scc1 KGqw
    ds_write2st64_b64 v120, v[192:193], v[194:195] offset0:0 offset1:2
    ds_write2st64_b64 v120, v[196:197], v[198:199] offset0:16 offset1:18
    ds_write2st64_b64 v120, v[200:201], v[202:203] offset0:32 offset1:34
    ds_write2st64_b64 v121, v[208:209], v[210:211] offset0:0 offset1:2
    ds_write2st64_b64 v121, v[212:213], v[214:215] offset0:16 offset1:18
    ds_write2st64_b64 v121, v[216:217], v[218:219] offset0:32 offset1:34
    s_mov_b64 exec, 0xffff
    v_mul_f32 v204, s66, v204
    v_and_b32 v228, 0xffff0000, v204
    v_maximum3_f32 v225, v225, abs(v204), abs(v204)
    v_sub_f32 v204, v204, v228
    v_cvt_pk_bf16_f32 v204, v204, v228
    ds_write2st64_b64 v120, v[204:205], v[206:207] offset0:48 offset1:50
    v_mul_f32 v220, s66, v220
    v_and_b32 v228, 0xffff0000, v220
    v_maximum3_f32 v225, v225, abs(v220), abs(v220)
    v_sub_f32 v220, v220, v228
    v_cvt_pk_bf16_f32 v220, v220, v228
    ds_write2st64_b64 v121, v[220:221], v[222:223] offset0:48 offset1:50
    s_mov_b64 exec, -1
    v_cmp_nge_f32 vcc, 0x40e80000, v225
    s_cbranch_vccz KGqq
    ds_write_b32 v238, v252 offset:256
KGqq:
    s_mov_b32 s28, s16
    s_and_b32 s29, s17, 0xffff
    s_mov_b32 s30, 3200000
    s_mov_b32 s31, 0x00020000
    v_lshrrev_b32 v1, 4, v157
    v_and_b32 v1, 2, v1
    v_xor_b32 v1, v1, v157
    v_and_b32 v1, 3, v1
    v_lshlrev_b32 v1, 4, v1
    v_lshrrev_b32 v2, 2, v157
    v_lshl_or_b32 v151, v2, 8, v1
    v_and_b32 v1, 15, v157
    v_lshrrev_b32 v2, 4, v157
    v_mul_u32_u24 v3, 272, v1
    s_lshr_b32 s84, s56, 2
    s_mul_i32 s85, s84, 8704
    v_lshl_add_u32 v3, v2, 4, v3
    v_add_u32 v136, s85, v3
    s_lshl_b32 s4, s84, 21
    s_lshl_b32 s84, s56, 11
    s_add_u32 s84, s84, 131072
    v_lshrrev_b32 v3, 1, v157
    v_xor_b32 v2, v2, v3
    v_and_b32 v2, 3, v2
    v_lshl_add_u32 v2, v2, 4, s84
    v_lshl_add_u32 v137, v1, 6, v2
    v_and_b32 v2, 12, v1
    v_lshl_add_u32 v2, v2, 2, s84
    v_and_b32 v3, 3, v1
    v_lshl_add_u32 v138, v3, 1, v2
    v_lshl_add_u32 v139, v157, 4, s84
    v_lshrrev_b32 v2, 3, v157
    v_xor_b32 v2, v2, v157
    v_and_b32 v2, 3, v2
    v_lshlrev_b32 v2, 4, v2
    v_lshrrev_b32 v3, 2, v157
    v_lshl_add_u32 v140, v3, 16, v2
    s_lshl_b32 s84, s57, 8
    s_add_u32 s4, s4, s84
    s_lshl_b32 s84, s74, 6
    s_add_u32 s4, s4, s84
    s_add_u32 s5, s4, 1048576
    s_mul_i32 s84, s56, 272
    v_lshl_add_u32 v142, v157, 2, s84
    v_lshlrev_b32 v150, 1, v156
    v_and_b32 v1, 31, v157
    v_lshlrev_b32 v1, 4, v1
    v_lshlrev_b32 v2, 5, v157
    v_and_b32 v2, 0x400, v2
    v_add3_u32 v145, v1, v2, s80
    v_cndmask_b32 v148, 0, 16, s[78:79]
    v_cndmask_b32 v149, 16, 0, s[78:79]
    v_sub_u32 v2, v154, v156
    v_add_u32 v2, 2144, v2
    v_mov_b32 v1, 464
    v_cndmask_b32 v146, v1, v2, s[78:79]
    v_cndmask_b32 v147, v2, v1, s[78:79]
    s_branch KG_w3_
KG_w3:
    s_sleep 1
KG_w3_:
    ds_read_b32 v1, v238 offset:276
    s_waitcnt lgkmcnt(0)
    v_readfirstlane_b32 s85, v1
    s_and_b32 s85, s85, 255
    s_cmp_lt_u32 s85, 4
    s_cbranch_scc1 KG_w3
    v_lshlrev_b32 v1, 3, v157
    ds_read_b64 v[12:13], v1 offset:31744
    ds_read_b64 v[18:19], v1 offset:32256
    ds_read_b64 v[20:21], v1 offset:32768
    ds_read_b64 v[26:27], v1 offset:33280
    ds_read_b64_tr_b16 v[160:161], v143 offset:32768
    ds_read_b64_tr_b16 v[162:163], v143 offset:33024
    ds_read_b64_tr_b16 v[164:165], v143 offset:34816
    ds_read_b64_tr_b16 v[166:167], v143 offset:35072
    ds_read_b64_tr_b16 v[168:169], v143 offset:36864
    ds_read_b64_tr_b16 v[170:171], v143 offset:37120
    ds_read_b64_tr_b16 v[172:173], v143 offset:38912
    ds_read_b64_tr_b16 v[174:175], v143 offset:39168
    ds_read_b64_tr_b16 v[176:177], v143 offset:32776
    ds_read_b64_tr_b16 v[178:179], v143 offset:33032
    ds_read_b64_tr_b16 v[180:181], v143 offset:34824
    ds_read_b64_tr_b16 v[182:183], v143 offset:35080
    ds_read_b64_tr_b16 v[184:185], v143 offset:36872
    ds_read_b64_tr_b16 v[186:187], v143 offset:37128
    ds_read_b64_tr_b16 v[188:189], v143 offset:38920
    ds_read_b64_tr_b16 v[190:191], v143 offset:39176
    s_waitcnt lgkmcnt(0)
    v_mfma_f32_16x16x32_bf16 v[208:211], v[160:163], v[60:63], 0
    v_mfma_f32_16x16x32_bf16 v[208:211], v[164:167], v[64:67], v[208:211]
    v_mfma_f32_16x16x32_bf16 v[208:211], v[168:171], v[68:71], v[208:211]
    v_mfma_f32_16x16x32_bf16 v[208:211], v[172:175], v[72:75], v[208:211]
    v_mfma_f32_16x16x32_bf16 v[212:215], v[176:179], v[60:63], 0
    v_mfma_f32_16x16x32_bf16 v[212:215], v[180:183], v[64:67], v[212:215]
    v_mfma_f32_16x16x32_bf16 v[212:215], v[184:187], v[68:71], v[212:215]
    v_mfma_f32_16x16x32_bf16 v[212:215], v[188:191], v[72:75], v[212:215]
    v_mfma_f32_16x16x32_bf16 v[216:219], v[76:79], v[160:163], 0
    v_mfma_f32_16x16x32_bf16 v[216:219], v[80:83], v[164:167], v[216:219]
    v_mfma_f32_16x16x32_bf16 v[216:219], v[84:87], v[168:171], v[216:219]
    v_mfma_f32_16x16x32_bf16 v[216:219], v[88:91], v[172:175], v[216:219]
    v_mfma_f32_16x16x32_bf16 v[220:223], v[76:79], v[176:179], 0
    v_mfma_f32_16x16x32_bf16 v[220:223], v[80:83], v[180:183], v[220:223]
    v_mfma_f32_16x16x32_bf16 v[220:223], v[84:87], v[184:187], v[220:223]
    v_mfma_f32_16x16x32_bf16 v[220:223], v[88:91], v[188:191], v[220:223]
    s_nop 4
    v_pk_mul_f32 v[208:209], v[208:209], s[66:67]
    v_pk_mul_f32 v[210:211], v[210:211], s[66:67]
    v_pk_mul_f32 v[212:213], v[212:213], s[66:67]
    v_pk_mul_f32 v[214:215], v[214:215], s[66:67]
    v_pk_mul_f32 v[216:217], v[216:217], s[66:67]
    v_pk_mul_f32 v[220:221], v[220:221], s[66:67]
    s_branch KG_b2_
KG_b2:
    s_sleep 1
KG_b2_:
    ds_read_b32 v1, v238 offset:292
    s_waitcnt lgkmcnt(0)
    v_readfirstlane_b32 s85, v1
    s_and_b32 s85, s85, 255
    s_cmp_lt_u32 s85, 16
    s_cbranch_scc1 KG_b2
    s_and_b32 s77, s2, 7
    s_lshl_b32 s77, s77, 10
    s_add_u32 s77, s77, 58269696
    s_add_u32 s77, s77, s23
    v_lshlrev_b32 v110, 2, v108
    buffer_load_dword v116, v110, s[36:39], s77 offen sc1
    s_mul_i32 s85, s74, 28
    v_mov_b32 v1, s85
    s_lshl_b32 s85, s85, 6
    v_lshl_add_u32 v117, v157, 2, s85
    ds_read_b32 v1, v1
    ds_read_u16 v2, v117 offset:60416
    v_mov_b32 v3, 0
    s_waitcnt lgkmcnt(0)
    v_cmp_lt_u32 vcc, v117, v1
    s_or_b64 exec, vcc, 1
    buffer_load_dword v239, v[2:3], s[24:27], 0 idxen offen offset:3072 sc1
    s_mov_b64 exec, -1
    s_mov_b32 s3, -1
    s_or_b32 s85, s72, 2
    s_waitcnt vmcnt(1)
KS_m:
    v_or_b32 v2, 2, v116
    v_cmp_ne_u32 vcc, s85, v2
    s_cbranch_vccz KS_n
    s_sub_u32 s73, s73, 1
    s_cbranch_scc1 KS_n
    s_sleep 8
    s_mov_b64 exec, vcc
    buffer_load_dword v116, v110, s[36:39], s77 offen sc1
    s_mov_b64 exec, -1
    s_waitcnt vmcnt(0)
    s_branch KS_m
KS_n:
    v_cmp_ne_u32 vcc, s72, v116
    s_cbranch_vccz KS_o
    ds_write_b32 v238, v252 offset:256
KS_o:
    s_setprio 3
    s_waitcnt lgkmcnt(0)
    s_barrier
    ds_read_b32 v1, v238 offset:296
    s_waitcnt lgkmcnt(0)
    v_readfirstlane_b32 s60, v1
    s_lshr_b32 s64, s60, 3
    s_mul_i32 s65, s64, s56
    s_and_b32 s86, s60, 7
    s_min_u32 s87, s86, s56
    s_add_u32 s65, s65, s87
    s_cmp_lt_u32 s56, s86
    s_addc_u32 s64, s64, 0
    s_lshl_b32 s84, s65, 7
    s_lshl_b32 s86, s65, 4
    v_add_u32 v153, s86, v153
    v_add_u32 v152, s86, v152
    s_add_u32 s87, s65, s64
    v_min_u32 v1, 8, v157
    v_sub_u32 v1, s87, v1
    v_lshlrev_b32 v1, 4, v1
    v_max_i32 v1, 0, v1
KF_J:
    ds_read_u16 v232, v153 offset:928
    ds_read_u16 v234, v152 offset:928
    ds_read_u16 v158, v1 offset:928
    ds_read_b32 v120, v238 offset:256
    s_waitcnt lgkmcnt(3)
    ds_read_u16 v128, v232 offset:60416
    ds_read_u16 v130, v232 offset:60420
    ds_read_u16 v132, v232 offset:60424
    ds_read_u16 v134, v232 offset:60428
    s_waitcnt lgkmcnt(0)
    s_mov_b32 m0, s61
    s_nop 0
    buffer_load_dwordx4 v[128:129], s[24:27], 0 idxen offen offset:0 sc1 lds
    buffer_load_dwordx4 v[130:131], s[24:27], 0 idxen offen offset:1024 sc1 lds
    buffer_load_dwordx4 v[132:133], s[24:27], 0 idxen offen offset:2048 sc1 lds
    buffer_load_dwordx4 v[134:135], s[24:27], 0 idxen offen offset:3072 sc1 lds
    s_add_u32 m0, s61, 4096
    s_nop 0
    buffer_load_dwordx4 v[128:129], s[24:27], s81 idxen offen offset:0 sc1 lds
    buffer_load_dwordx4 v[130:131], s[24:27], s81 idxen offen offset:1024 sc1 lds
    buffer_load_dwordx4 v[132:133], s[24:27], s81 idxen offen offset:2048 sc1 lds
    buffer_load_dwordx4 v[134:135], s[24:27], s81 idxen offen offset:3072 sc1 lds
    v_readlane_b32 s83, v158, s64
    v_readfirstlane_b32 s87, v120
    v_lshl_add_u32 v235, v234, 1, v237
    v_add_u32 v234, v234, v236
    ds_read_u16 v155, v234 offset:60418
    ds_read_u16 v232, v153 offset:944
    s_waitcnt lgkmcnt(0)
    ds_read_u16 v128, v232 offset:60416
    ds_read_u16 v130, v232 offset:60420
    ds_read_u16 v132, v232 offset:60424
    ds_read_u16 v134, v232 offset:60428
    s_cmp_lg_u32 s87, 0
    s_cbranch_scc1 KF_SLOW
    s_lshr_b32 s83, s83, 8
    v_subrev_u32 v2, s83, v157
    v_and_b32 v2, 15, v2
    v_add_u32 v159, s83, v2
    v_lshlrev_b32 v2, 2, v159
    ds_read_b32 v120, v2 offset:1872
    s_and_b32 s62, s83, -2
    s_lshl_b32 s62, s62, 3
    s_sub_u32 s63, 0, s62
    v_add3_u32 v155, v155, v150, s63
    v_lshl_add_u32 v250, s62, 6, v145
    ds_read_b128 v[14:17], v250
    ds_read_b128 v[22:25], v250 offset:512
    ds_read_b64 v[244:245], v235
    ds_read_b64 v[246:247], v155 offset:400
    ds_read_b64 v[248:249], v235
    ds_read_u16 v234, v152 offset:944
    v_lshrrev_b32 v158, 9, v158
    v_lshlrev_b32 v158, 4, v158
    v_mov_b32 v124, 0
    v_mov_b32 v125, 0
    v_mov_b32 v126, 0
    v_mov_b32 v127, 0
    v_mad_u32_u24 v146, v148, s65, v146
    v_mad_u32_u24 v147, v149, s65, v147
    s_add_u32 s85, s65, s64
    s_lshl_b32 s85, s85, 7
    s_add_u32 s86, s56, 48
    v_mov_b32 v1, s86
    v_mfma_f32_32x32x16_bf16 v[176:191], v[124:127], v[124:127], 0
    s_waitcnt lgkmcnt(0)
    v_lshl_add_u32 v235, v234, 1, v237
    v_add_u32 v234, v234, v236
    ds_read_u16 v155, v234 offset:60418
    ds_read_u16 v232, v153 offset:960
    v_cmp_gt_u32 vcc, s84, v120
    v_cmp_gt_u32 s[86:87], s85, v120
    v_cmp_gt_u32 s[84:85], s58, v159
    v_cndmask_b32 v159, v159, v1, vcc
    s_cmp_lg_u64 vcc, 0
    s_cselect_b32 s82, 1, 0
    s_and_b64 vcc, s[86:87], s[84:85]
    v_lshlrev_b32 v1, 2, v157
    v_cndmask_b32 v159, 56, v159, vcc
    v_lshrrev_b32 v2, 1, v157
    v_mul_u32_u24 v159, 272, v159
    v_and_b32 v2, 24, v2
    v_add_u32 v159, v159, v2
    s_mul_i32 s84, s83, 272
    v_add_u32 v141, s84, v1
    s_sub_u32 s64, s64, 1
    s_mov_b32 m0, s61
    s_waitcnt vmcnt(4)
    ds_read_b128 v[28:31], v144 offset:0
    ds_read_b128 v[32:35], v144 offset:2048
    ds_read_b128 v[36:39], v144 offset:256
    ds_read_b128 v[40:43], v144 offset:2304
    s_waitcnt lgkmcnt(0)
    v_mfma_f32_4x4x4_16b_bf16 v[60:63], v[28:29], v[4:5], 0
    v_mfma_f32_4x4x4_16b_bf16 v[64:67], v[32:33], v[4:5], 0
    v_mfma_f32_4x4x4_16b_bf16 v[68:71], v[36:37], v[4:5], 0
    v_mfma_f32_4x4x4_16b_bf16 v[72:75], v[40:41], v[4:5], 0
    s_nop 3
    v_mfma_f32_32x32x16_bf16 v[60:75], v[244:247], v[12:15], v[60:75]
    s_nop 9
    v_readlane_b32 s62, v158, s64
    v_mfma_f32_4x4x4_16b_bf16 v[76:79], v[30:31], v[4:5], 0
    v_exp_f32 v96, v60
    v_mfma_f32_4x4x4_16b_bf16 v[80:83], v[34:35], v[4:5], 0
    v_exp_f32 v97, v61
    v_mfma_f32_4x4x4_16b_bf16 v[84:87], v[38:39], v[4:5], 0
    v_exp_f32 v98, v62
    v_mfma_f32_4x4x4_16b_bf16 v[88:91], v[42:43], v[4:5], 0
    v_exp_f32 v99, v63
    v_exp_f32 v104, v68
    v_exp_f32 v105, v69
    v_exp_f32 v106, v70
    v_mfma_f32_32x32x16_bf16 v[76:91], v[246:249], v[16:19], v[76:91]
    v_exp_f32 v107, v71
    v_exp_f32 v100, v64
    v_exp_f32 v101, v65
    v_exp_f32 v108, v72
    buffer_load_dwordx4 v[128:129], s[24:27], 0 idxen offen offset:0 sc1 lds
    buffer_load_dwordx4 v[130:131], s[24:27], 0 idxen offen offset:1024 sc1 lds
    buffer_load_dwordx4 v[132:133], s[24:27], 0 idxen offen offset:2048 sc1 lds
    buffer_load_dwordx4 v[134:135], s[24:27], 0 idxen offen offset:3072 sc1 lds
    v_pk_add_f32 v[116:117], v[96:97], 1.0 op_sel_hi:[1,0]
    v_pk_add_f32 v[118:119], v[104:105], 1.0 op_sel_hi:[1,0]
    v_exp_f32 v109, v73
    v_pk_fma_f32 v[112:113], v[60:61], v[98:99], v[60:61]
    v_pk_fma_f32 v[114:115], v[68:69], v[106:107], v[68:69]
    v_pk_fma_f32 v[112:113], v[62:63], v[116:117], v[112:113]
    v_exp_f32 v102, v66
    v_pk_fma_f32 v[114:115], v[70:71], v[118:119], v[114:115]
    v_pk_fma_f32 v[116:117], v[116:117], v[98:99], v[116:117]
    v_pk_fma_f32 v[118:119], v[118:119], v[106:107], v[118:119]
    v_exp_f32 v103, v67
    v_pk_fma_f32 v[112:113], v[112:113], v[100:101], v[112:113]
    v_pk_fma_f32 v[114:115], v[114:115], v[108:109], v[114:115]
    s_waitcnt vmcnt(4)
    ds_read_b128 v[44:47], v144 offset:4096
    ds_read_b128 v[48:51], v144 offset:6144
    ds_read_b128 v[52:55], v144 offset:4352
    ds_read_b128 v[56:59], v144 offset:6400
    v_pk_fma_f32 v[112:113], v[64:65], v[116:117], v[112:113]
    v_exp_f32 v110, v74
    v_pk_fma_f32 v[114:115], v[72:73], v[118:119], v[114:115]
    v_pk_fma_f32 v[116:117], v[116:117], v[100:101], v[116:117]
    v_exp_f32 v111, v75
    v_pk_fma_f32 v[118:119], v[118:119], v[108:109], v[118:119]
    v_pk_fma_f32 v[112:113], v[112:113], v[102:103], v[112:113]
    v_pk_fma_f32 v[114:115], v[114:115], v[110:111], v[114:115]
    v_pk_fma_f32 v[112:113], v[66:67], v[116:117], v[112:113]
    v_pk_fma_f32 v[114:115], v[74:75], v[118:119], v[114:115]
    v_pk_fma_f32 v[116:117], v[116:117], v[102:103], v[116:117]
    v_pk_fma_f32 v[118:119], v[118:119], v[110:111], v[118:119]
    s_waitcnt lgkmcnt(0)
    v_mfma_f32_4x4x4_16b_bf16 v[60:63], v[44:45], v[4:5], 0
    v_rcp_f32 v116, v116
    v_mfma_f32_4x4x4_16b_bf16 v[64:67], v[48:49], v[4:5], 0
    v_rcp_f32 v117, v117
    v_mfma_f32_4x4x4_16b_bf16 v[68:71], v[52:53], v[4:5], 0
    v_rcp_f32 v118, v118
    v_mfma_f32_4x4x4_16b_bf16 v[72:75], v[56:57], v[4:5], 0
    v_rcp_f32 v119, v119
    v_exp_f32 v96, v76
    v_exp_f32 v97, v77
    v_exp_f32 v98, v78
    v_mfma_f32_32x32x16_bf16 v[60:75], v[244:247], v[20:23], v[60:75]
    v_exp_f32 v99, v79
    v_exp_f32 v104, v84
    v_exp_f32 v105, v85
    v_exp_f32 v106, v86
    s_add_u32 m0, s61, 4096
    s_nop 0
    buffer_load_dwordx4 v[128:129], s[24:27], s81 idxen offen offset:0 sc1 lds
    buffer_load_dwordx4 v[130:131], s[24:27], s81 idxen offen offset:1024 sc1 lds
    buffer_load_dwordx4 v[132:133], s[24:27], s81 idxen offen offset:2048 sc1 lds
    buffer_load_dwordx4 v[134:135], s[24:27], s81 idxen offen offset:3072 sc1 lds
    s_mov_b32 m0, s61
    ds_read_u16 v128, v232 offset:60416
    ds_read_u16 v130, v232 offset:60420
    ds_read_u16 v132, v232 offset:60424
    ds_read_u16 v134, v232 offset:60428
    v_pk_mul_f32 v[112:113], v[112:113], v[116:117]
    v_pk_mul_f32 v[114:115], v[114:115], v[118:119]
    v_cvt_pk_bf16_f32 v120, v112, v113
    v_cvt_pk_bf16_f32 v121, v114, v115
    v_pk_add_f32 v[116:117], v[96:97], 1.0 op_sel_hi:[1,0]
    v_exp_f32 v107, v87
    v_pk_add_f32 v[118:119], v[104:105], 1.0 op_sel_hi:[1,0]
    v_exp_f32 v100, v80
    v_pk_fma_f32 v[112:113], v[76:77], v[98:99], v[76:77]
    v_exp_f32 v101, v81
    v_pk_fma_f32 v[114:115], v[84:85], v[106:107], v[84:85]
    v_exp_f32 v108, v88
    v_pk_fma_f32 v[112:113], v[78:79], v[116:117], v[112:113]
    v_exp_f32 v109, v89
    v_pk_fma_f32 v[114:115], v[86:87], v[118:119], v[114:115]
    v_pk_fma_f32 v[116:117], v[116:117], v[98:99], v[116:117]
    v_exp_f32 v102, v82
    v_pk_fma_f32 v[118:119], v[118:119], v[106:107], v[118:119]
    v_pk_fma_f32 v[112:113], v[112:113], v[100:101], v[112:113]
    v_exp_f32 v103, v83
    v_pk_fma_f32 v[114:115], v[114:115], v[108:109], v[114:115]
    v_pk_fma_f32 v[112:113], v[80:81], v[116:117], v[112:113]
    v_exp_f32 v110, v90
    v_pk_fma_f32 v[114:115], v[88:89], v[118:119], v[114:115]
    v_pk_fma_f32 v[116:117], v[116:117], v[100:101], v[116:117]
    v_exp_f32 v111, v91
    v_pk_fma_f32 v[118:119], v[118:119], v[108:109], v[118:119]
    v_pk_fma_f32 v[112:113], v[112:113], v[102:103], v[112:113]
    v_pk_fma_f32 v[114:115], v[114:115], v[110:111], v[114:115]
    v_pk_fma_f32 v[112:113], v[82:83], v[116:117], v[112:113]
    v_pk_fma_f32 v[114:115], v[90:91], v[118:119], v[114:115]
    v_pk_fma_f32 v[116:117], v[116:117], v[102:103], v[116:117]
    v_pk_fma_f32 v[118:119], v[118:119], v[110:111], v[118:119]
    v_mfma_f32_4x4x4_16b_bf16 v[76:79], v[46:47], v[4:5], 0
    v_rcp_f32 v116, v116
    v_mfma_f32_4x4x4_16b_bf16 v[80:83], v[50:51], v[4:5], 0
    v_rcp_f32 v117, v117
    v_mfma_f32_4x4x4_16b_bf16 v[84:87], v[54:55], v[4:5], 0
    v_rcp_f32 v118, v118
    v_mfma_f32_4x4x4_16b_bf16 v[88:91], v[58:59], v[4:5], 0
    v_rcp_f32 v119, v119
    v_exp_f32 v96, v60
    v_exp_f32 v97, v61
    v_exp_f32 v98, v62
    v_mfma_f32_32x32x16_bf16 v[76:91], v[246:249], v[24:27], v[76:91]
    v_exp_f32 v99, v63
    s_sub_u32 s63, 0, s62
    s_waitcnt vmcnt(0) lgkmcnt(0)
    v_add3_u32 v155, v155, v150, s63
    v_lshl_add_u32 v250, s62, 6, v145
    ds_read_u16 v234, v152 offset:960
    ds_read_u16 v232, v153 offset:976
    ds_read_b128 v[14:17], v250
    ds_read_b128 v[22:25], v250 offset:512
    ds_read_b64 v[244:245], v235
    ds_read_b64 v[246:247], v155 offset:400
    ds_read_b64 v[248:249], v235
    ds_read_b64 v[124:125], v146
    ds_read_b64 v[126:127], v147
    ds_read_b128 v[28:31], v144 offset:0
    ds_read_b128 v[32:35], v144 offset:2048
    ds_read_b128 v[36:39], v144 offset:256
    ds_read_b128 v[40:43], v144 offset:2304
    ds_read_b128 v[44:47], v144 offset:4096
    ds_read_b128 v[48:51], v144 offset:6144
    ds_read_b128 v[52:55], v144 offset:4352
    ds_read_b128 v[56:59], v144 offset:6400
    v_exp_f32 v104, v68
    v_exp_f32 v105, v69
    v_exp_f32 v106, v70
    v_pk_mul_f32 v[112:113], v[112:113], v[116:117]
    v_pk_mul_f32 v[114:115], v[114:115], v[118:119]
    v_cvt_pk_bf16_f32 v122, v112, v113
    v_cvt_pk_bf16_f32 v123, v114, v115
    v_pk_add_f32 v[116:117], v[96:97], 1.0 op_sel_hi:[1,0]
    v_exp_f32 v107, v71
    v_pk_add_f32 v[118:119], v[104:105], 1.0 op_sel_hi:[1,0]
    v_exp_f32 v100, v64
    v_pk_fma_f32 v[112:113], v[60:61], v[98:99], v[60:61]
    v_exp_f32 v101, v65
    v_pk_fma_f32 v[114:115], v[68:69], v[106:107], v[68:69]
    v_exp_f32 v108, v72
    v_pk_fma_f32 v[112:113], v[62:63], v[116:117], v[112:113]
    v_exp_f32 v109, v73
    v_pk_fma_f32 v[114:115], v[70:71], v[118:119], v[114:115]
    v_pk_fma_f32 v[116:117], v[116:117], v[98:99], v[116:117]
    v_exp_f32 v102, v66
    v_pk_fma_f32 v[118:119], v[118:119], v[106:107], v[118:119]
    v_pk_fma_f32 v[112:113], v[112:113], v[100:101], v[112:113]
    v_exp_f32 v103, v67
    v_pk_fma_f32 v[114:115], v[114:115], v[108:109], v[114:115]
    v_pk_fma_f32 v[112:113], v[64:65], v[116:117], v[112:113]
    v_exp_f32 v110, v74
    v_pk_fma_f32 v[114:115], v[72:73], v[118:119], v[114:115]
    v_pk_fma_f32 v[116:117], v[116:117], v[100:101], v[116:117]
    v_exp_f32 v111, v75
    v_pk_fma_f32 v[118:119], v[118:119], v[108:109], v[118:119]
    v_pk_fma_f32 v[112:113], v[112:113], v[102:103], v[112:113]
    v_pk_fma_f32 v[114:115], v[114:115], v[110:111], v[114:115]
    v_pk_fma_f32 v[112:113], v[66:67], v[116:117], v[112:113]
    v_pk_fma_f32 v[114:115], v[74:75], v[118:119], v[114:115]
    v_pk_fma_f32 v[116:117], v[116:117], v[102:103], v[116:117]
    v_pk_fma_f32 v[118:119], v[118:119], v[110:111], v[118:119]
    v_pk_add_f32 v[152:153], v[152:153], s[68:69]
    v_pk_add_f32 v[146:147], v[146:147], v[148:149]
    s_waitcnt lgkmcnt(0)
    v_mfma_f32_4x4x4_16b_bf16 v[60:63], v[28:29], v[4:5], 0
    v_rcp_f32 v116, v116
    v_mfma_f32_4x4x4_16b_bf16 v[64:67], v[32:33], v[4:5], 0
    v_rcp_f32 v117, v117
    v_mfma_f32_4x4x4_16b_bf16 v[68:71], v[36:37], v[4:5], 0
    v_rcp_f32 v118, v118
    v_mfma_f32_4x4x4_16b_bf16 v[72:75], v[40:41], v[4:5], 0
    v_rcp_f32 v119, v119
    v_mfma_f32_32x32x16_bf16 v[160:175], v[120:123], v[124:127], 0
    v_exp_f32 v96, v76
    v_exp_f32 v97, v77
    v_exp_f32 v98, v78
    v_exp_f32 v99, v79
    v_mfma_f32_32x32x16_bf16 v[60:75], v[244:247], v[12:15], v[60:75]
    v_exp_f32 v104, v84
    v_exp_f32 v105, v85
    v_exp_f32 v106, v86
    v_exp_f32 v107, v87
    v_lshl_add_u32 v235, v234, 1, v237
    v_add_u32 v234, v234, v236
    buffer_load_dwordx4 v[128:129], s[24:27], 0 idxen offen offset:0 sc1 lds
    buffer_load_dwordx4 v[130:131], s[24:27], 0 idxen offen offset:1024 sc1 lds
    buffer_load_dwordx4 v[132:133], s[24:27], 0 idxen offen offset:2048 sc1 lds
    buffer_load_dwordx4 v[134:135], s[24:27], 0 idxen offen offset:3072 sc1 lds
    s_add_u32 m0, s61, 4096
    ds_read_u16 v155, v234 offset:60418
    buffer_load_dwordx4 v[128:129], s[24:27], s81 idxen offen offset:0 sc1 lds
    buffer_load_dwordx4 v[130:131], s[24:27], s81 idxen offen offset:1024 sc1 lds
    buffer_load_dwordx4 v[132:133], s[24:27], s81 idxen offen offset:2048 sc1 lds
    buffer_load_dwordx4 v[134:135], s[24:27], s81 idxen offen offset:3072 sc1 lds
    s_mov_b32 m0, s61
    ds_read_u16 v128, v232 offset:60416
    ds_read_u16 v130, v232 offset:60420
    ds_read_u16 v132, v232 offset:60424
    ds_read_u16 v134, v232 offset:60428
    v_pk_mul_f32 v[112:113], v[112:113], v[116:117]
    v_pk_mul_f32 v[114:115], v[114:115], v[118:119]
    v_cvt_pk_bf16_f32 v120, v112, v113
    v_cvt_pk_bf16_f32 v121, v114, v115
    v_pk_add_f32 v[116:117], v[96:97], 1.0 op_sel_hi:[1,0]
    v_exp_f32 v100, v80
    v_pk_add_f32 v[118:119], v[104:105], 1.0 op_sel_hi:[1,0]
    v_exp_f32 v101, v81
    v_pk_fma_f32 v[112:113], v[76:77], v[98:99], v[76:77]
    v_exp_f32 v108, v88
    v_pk_fma_f32 v[114:115], v[84:85], v[106:107], v[84:85]
    v_exp_f32 v109, v89
    v_pk_fma_f32 v[112:113], v[78:79], v[116:117], v[112:113]
    v_pk_fma_f32 v[114:115], v[86:87], v[118:119], v[114:115]
    v_exp_f32 v102, v82
    v_pk_fma_f32 v[116:117], v[116:117], v[98:99], v[116:117]
    v_pk_fma_f32 v[118:119], v[118:119], v[106:107], v[118:119]
    v_exp_f32 v103, v83
    v_pk_fma_f32 v[112:113], v[112:113], v[100:101], v[112:113]
    v_pk_fma_f32 v[114:115], v[114:115], v[108:109], v[114:115]
    v_exp_f32 v110, v90
    v_pk_fma_f32 v[112:113], v[80:81], v[116:117], v[112:113]
    v_pk_fma_f32 v[114:115], v[88:89], v[118:119], v[114:115]
    v_exp_f32 v111, v91
    v_pk_fma_f32 v[116:117], v[116:117], v[100:101], v[116:117]
    v_pk_fma_f32 v[118:119], v[118:119], v[108:109], v[118:119]
    v_pk_fma_f32 v[112:113], v[112:113], v[102:103], v[112:113]
    v_pk_fma_f32 v[114:115], v[114:115], v[110:111], v[114:115]
    v_pk_fma_f32 v[112:113], v[82:83], v[116:117], v[112:113]
    v_pk_fma_f32 v[114:115], v[90:91], v[118:119], v[114:115]
    v_pk_fma_f32 v[116:117], v[116:117], v[102:103], v[116:117]
    v_pk_fma_f32 v[118:119], v[118:119], v[110:111], v[118:119]
    s_branch KF_LE
    .p2align 6
KF_LOOP:
    v_readlane_b32 s62, v158, s64
    v_mfma_f32_4x4x4_16b_bf16 v[76:79], v[30:31], v[4:5], 0
    v_rcp_f32 v116, v116
    v_mfma_f32_4x4x4_16b_bf16 v[80:83], v[34:35], v[4:5], 0
    v_rcp_f32 v117, v117
    v_mfma_f32_4x4x4_16b_bf16 v[84:87], v[38:39], v[4:5], 0
    v_rcp_f32 v118, v118
    v_mfma_f32_4x4x4_16b_bf16 v[88:91], v[42:43], v[4:5], 0
    v_rcp_f32 v119, v119
    v_exp_f32 v96, v60
    v_exp_f32 v97, v61
    v_exp_f32 v98, v62
    v_mfma_f32_32x32x16_bf16 v[76:91], v[246:249], v[16:19], v[76:91]
    v_exp_f32 v99, v63
    v_exp_f32 v104, v68
    v_exp_f32 v105, v69
    v_exp_f32 v106, v70
    v_pk_mul_f32 v[112:113], v[112:113], v[116:117]
    v_pk_mul_f32 v[114:115], v[114:115], v[118:119]
    v_cvt_pk_bf16_f32 v122, v112, v113
    v_cvt_pk_bf16_f32 v123, v114, v115
    v_pk_add_f32 v[116:117], v[96:97], 1.0 op_sel_hi:[1,0]
    v_exp_f32 v107, v71
    v_pk_add_f32 v[118:119], v[104:105], 1.0 op_sel_hi:[1,0]
    v_exp_f32 v100, v64
    v_pk_fma_f32 v[112:113], v[60:61], v[98:99], v[60:61]
    v_exp_f32 v101, v65
    v_pk_fma_f32 v[114:115], v[68:69], v[106:107], v[68:69]
    v_exp_f32 v108, v72
    v_pk_fma_f32 v[112:113], v[62:63], v[116:117], v[112:113]
    v_exp_f32 v109, v73
    v_pk_fma_f32 v[114:115], v[70:71], v[118:119], v[114:115]
    v_pk_fma_f32 v[116:117], v[116:117], v[98:99], v[116:117]
    v_exp_f32 v102, v66
    v_pk_fma_f32 v[118:119], v[118:119], v[106:107], v[118:119]
    v_pk_fma_f32 v[112:113], v[112:113], v[100:101], v[112:113]
    v_exp_f32 v103, v67
    v_pk_fma_f32 v[114:115], v[114:115], v[108:109], v[114:115]
    v_pk_fma_f32 v[112:113], v[64:65], v[116:117], v[112:113]
    v_exp_f32 v110, v74
    v_pk_fma_f32 v[114:115], v[72:73], v[118:119], v[114:115]
    v_pk_fma_f32 v[116:117], v[116:117], v[100:101], v[116:117]
    v_exp_f32 v111, v75
    v_pk_fma_f32 v[118:119], v[118:119], v[108:109], v[118:119]
    v_pk_fma_f32 v[112:113], v[112:113], v[102:103], v[112:113]
    v_pk_fma_f32 v[114:115], v[114:115], v[110:111], v[114:115]
    v_pk_fma_f32 v[112:113], v[66:67], v[116:117], v[112:113]
    v_pk_fma_f32 v[114:115], v[74:75], v[118:119], v[114:115]
    v_pk_fma_f32 v[116:117], v[116:117], v[102:103], v[116:117]
    v_pk_fma_f32 v[118:119], v[118:119], v[110:111], v[118:119]
    v_mfma_f32_4x4x4_16b_bf16 v[60:63], v[44:45], v[4:5], 0
    v_rcp_f32 v116, v116
    v_mfma_f32_4x4x4_16b_bf16 v[64:67], v[48:49], v[4:5], 0
    v_rcp_f32 v117, v117
    v_mfma_f32_4x4x4_16b_bf16 v[68:71], v[52:53], v[4:5], 0
    v_rcp_f32 v118, v118
    v_mfma_f32_4x4x4_16b_bf16 v[72:75], v[56:57], v[4:5], 0
    v_rcp_f32 v119, v119
    v_mfma_f32_32x32x16_bf16 v[176:191], v[120:123], v[124:127], v[176:191]
    v_exp_f32 v96, v76
    v_exp_f32 v97, v77
    v_exp_f32 v98, v78
    v_exp_f32 v99, v79
    v_mfma_f32_32x32x16_bf16 v[60:75], v[244:247], v[20:23], v[60:75]
    v_exp_f32 v104, v84
    v_exp_f32 v105, v85
    v_exp_f32 v106, v86
    v_exp_f32 v107, v87
    v_pk_mul_f32 v[112:113], v[112:113], v[116:117]
    v_pk_mul_f32 v[114:115], v[114:115], v[118:119]
    v_cvt_pk_bf16_f32 v120, v112, v113
    v_cvt_pk_bf16_f32 v121, v114, v115
    v_pk_add_f32 v[116:117], v[96:97], 1.0 op_sel_hi:[1,0]
    v_exp_f32 v100, v80
    v_pk_add_f32 v[118:119], v[104:105], 1.0 op_sel_hi:[1,0]
    v_exp_f32 v101, v81
    v_pk_fma_f32 v[112:113], v[76:77], v[98:99], v[76:77]
    v_exp_f32 v108, v88
    v_pk_fma_f32 v[114:115], v[84:85], v[106:107], v[84:85]
    v_exp_f32 v109, v89
    v_pk_fma_f32 v[112:113], v[78:79], v[116:117], v[112:113]
    v_pk_fma_f32 v[114:115], v[86:87], v[118:119], v[114:115]
    v_exp_f32 v102, v82
    v_pk_fma_f32 v[116:117], v[116:117], v[98:99], v[116:117]
    v_pk_fma_f32 v[118:119], v[118:119], v[106:107], v[118:119]
    v_exp_f32 v103, v83
    v_pk_fma_f32 v[112:113], v[112:113], v[100:101], v[112:113]
    v_pk_fma_f32 v[114:115], v[114:115], v[108:109], v[114:115]
    v_exp_f32 v110, v90
    v_pk_fma_f32 v[112:113], v[80:81], v[116:117], v[112:113]
    v_pk_fma_f32 v[114:115], v[88:89], v[118:119], v[114:115]
    v_exp_f32 v111, v91
    v_pk_fma_f32 v[116:117], v[116:117], v[100:101], v[116:117]
    v_pk_fma_f32 v[118:119], v[118:119], v[108:109], v[118:119]
    v_pk_fma_f32 v[112:113], v[112:113], v[102:103], v[112:113]
    v_pk_fma_f32 v[114:115], v[114:115], v[110:111], v[114:115]
    v_pk_fma_f32 v[112:113], v[82:83], v[116:117], v[112:113]
    v_pk_fma_f32 v[114:115], v[90:91], v[118:119], v[114:115]
    v_pk_fma_f32 v[116:117], v[116:117], v[102:103], v[116:117]
    v_pk_fma_f32 v[118:119], v[118:119], v[110:111], v[118:119]
    v_mfma_f32_4x4x4_16b_bf16 v[76:79], v[46:47], v[4:5], 0
    v_rcp_f32 v116, v116
    v_mfma_f32_4x4x4_16b_bf16 v[80:83], v[50:51], v[4:5], 0
    v_rcp_f32 v117, v117
    v_mfma_f32_4x4x4_16b_bf16 v[84:87], v[54:55], v[4:5], 0
    v_rcp_f32 v118, v118
    v_mfma_f32_4x4x4_16b_bf16 v[88:91], v[58:59], v[4:5], 0
    v_rcp_f32 v119, v119
    v_exp_f32 v96, v60
    v_exp_f32 v97, v61
    v_exp_f32 v98, v62
    v_mfma_f32_32x32x16_bf16 v[76:91], v[246:249], v[24:27], v[76:91]
    v_exp_f32 v99, v63
    s_sub_u32 s63, 0, s62
    s_waitcnt vmcnt(0) lgkmcnt(0)
    v_add3_u32 v155, v155, v150, s63
    v_lshl_add_u32 v250, s62, 6, v145
    ds_read_u16 v234, v152 offset:960
    ds_read_u16 v232, v153 offset:976
    ds_read_b128 v[14:17], v250
    ds_read_b128 v[22:25], v250 offset:512
    ds_read_b64 v[244:245], v235
    ds_read_b64 v[246:247], v155 offset:400
    ds_read_b64 v[248:249], v235
    ds_read_b64 v[124:125], v146
    ds_read_b64 v[126:127], v147
    ds_read_b128 v[28:31], v144 offset:0
    ds_read_b128 v[32:35], v144 offset:2048
    ds_read_b128 v[36:39], v144 offset:256
    ds_read_b128 v[40:43], v144 offset:2304
    ds_read_b128 v[44:47], v144 offset:4096
    ds_read_b128 v[48:51], v144 offset:6144
    ds_read_b128 v[52:55], v144 offset:4352
    ds_read_b128 v[56:59], v144 offset:6400
    v_exp_f32 v104, v68
    v_exp_f32 v105, v69
    v_exp_f32 v106, v70
    v_pk_mul_f32 v[112:113], v[112:113], v[116:117]
    v_pk_mul_f32 v[114:115], v[114:115], v[118:119]
    v_cvt_pk_bf16_f32 v122, v112, v113
    v_cvt_pk_bf16_f32 v123, v114, v115
    v_pk_add_f32 v[116:117], v[96:97], 1.0 op_sel_hi:[1,0]
    v_exp_f32 v107, v71
    v_pk_add_f32 v[118:119], v[104:105], 1.0 op_sel_hi:[1,0]
    v_exp_f32 v100, v64
    v_pk_fma_f32 v[112:113], v[60:61], v[98:99], v[60:61]
    v_exp_f32 v101, v65
    v_pk_fma_f32 v[114:115], v[68:69], v[106:107], v[68:69]
    v_exp_f32 v108, v72
    v_pk_fma_f32 v[112:113], v[62:63], v[116:117], v[112:113]
    v_exp_f32 v109, v73
    v_pk_fma_f32 v[114:115], v[70:71], v[118:119], v[114:115]
    v_pk_fma_f32 v[116:117], v[116:117], v[98:99], v[116:117]
    v_exp_f32 v102, v66
    v_pk_fma_f32 v[118:119], v[118:119], v[106:107], v[118:119]
    v_pk_fma_f32 v[112:113], v[112:113], v[100:101], v[112:113]
    v_exp_f32 v103, v67
    v_pk_fma_f32 v[114:115], v[114:115], v[108:109], v[114:115]
    v_pk_fma_f32 v[112:113], v[64:65], v[116:117], v[112:113]
    v_exp_f32 v110, v74
    v_pk_fma_f32 v[114:115], v[72:73], v[118:119], v[114:115]
    v_pk_fma_f32 v[116:117], v[116:117], v[100:101], v[116:117]
    v_exp_f32 v111, v75
    v_pk_fma_f32 v[118:119], v[118:119], v[108:109], v[118:119]
    v_pk_fma_f32 v[112:113], v[112:113], v[102:103], v[112:113]
    v_pk_fma_f32 v[114:115], v[114:115], v[110:111], v[114:115]
    v_pk_fma_f32 v[112:113], v[66:67], v[116:117], v[112:113]
    v_pk_fma_f32 v[114:115], v[74:75], v[118:119], v[114:115]
    v_pk_fma_f32 v[116:117], v[116:117], v[102:103], v[116:117]
    v_pk_fma_f32 v[118:119], v[118:119], v[110:111], v[118:119]
    v_pk_add_f32 v[152:153], v[152:153], s[68:69]
    v_pk_add_f32 v[146:147], v[146:147], v[148:149]
    s_waitcnt lgkmcnt(0)
    v_mfma_f32_4x4x4_16b_bf16 v[60:63], v[28:29], v[4:5], 0
    v_rcp_f32 v116, v116
    v_mfma_f32_4x4x4_16b_bf16 v[64:67], v[32:33], v[4:5], 0
    v_rcp_f32 v117, v117
    v_mfma_f32_4x4x4_16b_bf16 v[68:71], v[36:37], v[4:5], 0
    v_rcp_f32 v118, v118
    v_mfma_f32_4x4x4_16b_bf16 v[72:75], v[40:41], v[4:5], 0
    v_rcp_f32 v119, v119
    v_mfma_f32_32x32x16_bf16 v[160:175], v[120:123], v[124:127], v[160:175]
    v_exp_f32 v96, v76
    v_exp_f32 v97, v77
    v_exp_f32 v98, v78
    v_exp_f32 v99, v79
    v_mfma_f32_32x32x16_bf16 v[60:75], v[244:247], v[12:15], v[60:75]
    v_exp_f32 v104, v84
    v_exp_f32 v105, v85
    v_exp_f32 v106, v86
    v_exp_f32 v107, v87
    v_lshl_add_u32 v235, v234, 1, v237
    v_add_u32 v234, v234, v236
    s_cmp_gt_u32 s64, 1
    s_cbranch_scc0 KF_lt
    buffer_load_dwordx4 v[128:129], s[24:27], 0 idxen offen offset:0 sc1 lds
    buffer_load_dwordx4 v[130:131], s[24:27], 0 idxen offen offset:1024 sc1 lds
    buffer_load_dwordx4 v[132:133], s[24:27], 0 idxen offen offset:2048 sc1 lds
    buffer_load_dwordx4 v[134:135], s[24:27], 0 idxen offen offset:3072 sc1 lds
    s_add_u32 m0, s61, 4096
    ds_read_u16 v155, v234 offset:60418
    buffer_load_dwordx4 v[128:129], s[24:27], s81 idxen offen offset:0 sc1 lds
    buffer_load_dwordx4 v[130:131], s[24:27], s81 idxen offen offset:1024 sc1 lds
    buffer_load_dwordx4 v[132:133], s[24:27], s81 idxen offen offset:2048 sc1 lds
    buffer_load_dwordx4 v[134:135], s[24:27], s81 idxen offen offset:3072 sc1 lds
    s_mov_b32 m0, s61
    ds_read_u16 v128, v232 offset:60416
    ds_read_u16 v130, v232 offset:60420
    ds_read_u16 v132, v232 offset:60424
    ds_read_u16 v134, v232 offset:60428
KF_lb:
    v_pk_mul_f32 v[112:113], v[112:113], v[116:117]
    v_pk_mul_f32 v[114:115], v[114:115], v[118:119]
    v_cvt_pk_bf16_f32 v120, v112, v113
    v_cvt_pk_bf16_f32 v121, v114, v115
    v_pk_add_f32 v[116:117], v[96:97], 1.0 op_sel_hi:[1,0]
    v_exp_f32 v100, v80
    v_pk_add_f32 v[118:119], v[104:105], 1.0 op_sel_hi:[1,0]
    v_exp_f32 v101, v81
    v_pk_fma_f32 v[112:113], v[76:77], v[98:99], v[76:77]
    v_exp_f32 v108, v88
    v_pk_fma_f32 v[114:115], v[84:85], v[106:107], v[84:85]
    v_exp_f32 v109, v89
    v_pk_fma_f32 v[112:113], v[78:79], v[116:117], v[112:113]
    v_pk_fma_f32 v[114:115], v[86:87], v[118:119], v[114:115]
    v_exp_f32 v102, v82
    v_pk_fma_f32 v[116:117], v[116:117], v[98:99], v[116:117]
    v_pk_fma_f32 v[118:119], v[118:119], v[106:107], v[118:119]
    v_exp_f32 v103, v83
    v_pk_fma_f32 v[112:113], v[112:113], v[100:101], v[112:113]
    v_pk_fma_f32 v[114:115], v[114:115], v[108:109], v[114:115]
    v_exp_f32 v110, v90
    v_pk_fma_f32 v[112:113], v[80:81], v[116:117], v[112:113]
    v_pk_fma_f32 v[114:115], v[88:89], v[118:119], v[114:115]
    v_exp_f32 v111, v91
    v_pk_fma_f32 v[116:117], v[116:117], v[100:101], v[116:117]
    v_pk_fma_f32 v[118:119], v[118:119], v[108:109], v[118:119]
    v_pk_fma_f32 v[112:113], v[112:113], v[102:103], v[112:113]
    v_pk_fma_f32 v[114:115], v[114:115], v[110:111], v[114:115]
    v_pk_fma_f32 v[112:113], v[82:83], v[116:117], v[112:113]
    v_pk_fma_f32 v[114:115], v[90:91], v[118:119], v[114:115]
    v_pk_fma_f32 v[116:117], v[116:117], v[102:103], v[116:117]
    v_pk_fma_f32 v[118:119], v[118:119], v[110:111], v[118:119]
KF_LE:
    s_bitcmp1_b32 42, s64
    s_cbranch_scc1 KF_pr
KF_pb:
    s_sub_u32 s64, s64, 1
    s_cbranch_scc0 KF_LOOP
    s_lshl_b32 s84, s74, 2
    v_mov_b32 v1, s84
    s_cmp_ge_u32 s56, 4
    s_cbranch_scc1 KF_w0
    ds_write_b32 v1, v143 offset:320
    s_branch KF_w1
KF_w0:
    ds_read_b32 v2, v1 offset:320
    s_waitcnt lgkmcnt(0)
    v_cmp_eq_u32 vcc, 0, v2
    s_cbranch_vccnz KF_w0
KF_w1:
    ds_read_b64_tr_b16 v[28:29], v143 offset:0
    ds_read_b64_tr_b16 v[30:31], v143 offset:256
    ds_read_b64_tr_b16 v[32:33], v143 offset:2048
    ds_read_b64_tr_b16 v[34:35], v143 offset:2304
    ds_read_b64_tr_b16 v[36:37], v143 offset:4096
    ds_read_b64_tr_b16 v[38:39], v143 offset:4352
    ds_read_b64_tr_b16 v[40:41], v143 offset:6144
    ds_read_b64_tr_b16 v[42:43], v143 offset:6400
    ds_read_b64_tr_b16 v[44:45], v143 offset:8
    ds_read_b64_tr_b16 v[46:47], v143 offset:264
    ds_read_b64_tr_b16 v[48:49], v143 offset:2056
    ds_read_b64_tr_b16 v[50:51], v143 offset:2312
    ds_read_b64_tr_b16 v[52:53], v143 offset:4104
    ds_read_b64_tr_b16 v[54:55], v143 offset:4360
    ds_read_b64_tr_b16 v[56:57], v143 offset:6152
    ds_read_b64_tr_b16 v[58:59], v143 offset:6408
    v_rcp_f32 v116, v116
    v_rcp_f32 v117, v117
    v_rcp_f32 v118, v118
    v_rcp_f32 v119, v119
    s_nop 0
    v_pk_mul_f32 v[112:113], v[112:113], v[116:117]
    v_pk_mul_f32 v[114:115], v[114:115], v[118:119]
    v_cvt_pk_bf16_f32 v122, v112, v113
    v_cvt_pk_bf16_f32 v123, v114, v115
    s_nop 1
    v_mfma_f32_32x32x16_bf16 v[176:191], v[120:123], v[124:127], v[176:191]
    v_cvt_pk_bf16_f32 v160, v160, v161
    v_cvt_pk_bf16_f32 v161, v162, v163
    v_cvt_pk_bf16_f32 v164, v164, v165
    v_cvt_pk_bf16_f32 v165, v166, v167
    v_cvt_pk_bf16_f32 v168, v168, v169
    v_cvt_pk_bf16_f32 v169, v170, v171
    v_cvt_pk_bf16_f32 v172, v172, v173
    v_cvt_pk_bf16_f32 v173, v174, v175
    ds_write_b64 v159, v[160:161] offset:17408
    ds_write_b64 v159, v[164:165] offset:17440
    ds_write_b64 v159, v[168:169] offset:17472
    ds_write_b64 v159, v[172:173] offset:17504
    v_cvt_pk_bf16_f32 v176, v176, v177
    v_cvt_pk_bf16_f32 v177, v178, v179
    v_cvt_pk_bf16_f32 v180, v180, v181
    v_cvt_pk_bf16_f32 v181, v182, v183
    v_cvt_pk_bf16_f32 v184, v184, v185
    v_cvt_pk_bf16_f32 v185, v186, v187
    v_cvt_pk_bf16_f32 v188, v188, v189
    v_cvt_pk_bf16_f32 v189, v190, v191
    ds_write_b64 v159, v[176:177] offset:17536
    ds_write_b64 v159, v[180:181] offset:17568
    ds_write_b64 v159, v[184:185] offset:17600
    ds_write_b64 v159, v[188:189] offset:17632
    s_cmp_eq_u32 s82, 0
    s_waitcnt vmcnt(0) lgkmcnt(0)
    s_barrier
    s_cbranch_scc1 KF_FIN
    ds_read_b32 v4, v141 offset:17408
    ds_read_b32 v5, v142 offset:30464
    s_waitcnt lgkmcnt(0)
    v_lshlrev_b32 v6, 16, v4
    v_and_b32 v7, 0xffff0000, v4
    v_lshlrev_b32 v8, 16, v5
    v_and_b32 v9, 0xffff0000, v5
    v_pk_add_f32 v[6:7], v[6:7], v[8:9]
    v_cvt_pk_bf16_f32 v6, v6, v7
    ds_write_b32 v141, v6 offset:17408
KF_FIN:
    s_cmp_ge_u32 s56, 4
    s_waitcnt lgkmcnt(0)
    s_barrier
    ds_read_b128 v[60:63], v136 offset:17408
    ds_read_b128 v[64:67], v136 offset:17472
    ds_read_b128 v[68:71], v136 offset:17536
    ds_read_b128 v[72:75], v136 offset:17600
    ds_read_b128 v[76:79], v136 offset:21760
    ds_read_b128 v[80:83], v136 offset:21824
    ds_read_b128 v[84:87], v136 offset:21888
    ds_read_b128 v[88:91], v136 offset:21952
    s_waitcnt lgkmcnt(7)
    v_mfma_f32_16x16x32_bf16 v[208:211], v[28:31], v[60:63], v[208:211]
    v_mfma_f32_16x16x32_bf16 v[212:215], v[44:47], v[60:63], v[212:215]
    s_waitcnt lgkmcnt(6)
    v_mfma_f32_16x16x32_bf16 v[208:211], v[32:35], v[64:67], v[208:211]
    v_mfma_f32_16x16x32_bf16 v[212:215], v[48:51], v[64:67], v[212:215]
    s_waitcnt lgkmcnt(5)
    v_mfma_f32_16x16x32_bf16 v[208:211], v[36:39], v[68:71], v[208:211]
    v_mfma_f32_16x16x32_bf16 v[212:215], v[52:55], v[68:71], v[212:215]
    s_waitcnt lgkmcnt(4)
    v_mfma_f32_16x16x32_bf16 v[208:211], v[40:43], v[72:75], v[208:211]
    v_mfma_f32_16x16x32_bf16 v[212:215], v[56:59], v[72:75], v[212:215]
    s_waitcnt lgkmcnt(0)
    s_cbranch_scc1 KF_eg
    v_mfma_f32_16x16x32_bf16 v[216:219], v[28:31], v[76:79], v[216:219]
    v_mfma_f32_16x16x32_bf16 v[220:223], v[44:47], v[76:79], v[220:223]
    v_mfma_f32_16x16x32_bf16 v[216:219], v[32:35], v[80:83], v[216:219]
    v_mfma_f32_16x16x32_bf16 v[220:223], v[48:51], v[80:83], v[220:223]
    v_mfma_f32_16x16x32_bf16 v[216:219], v[36:39], v[84:87], v[216:219]
    v_mfma_f32_16x16x32_bf16 v[220:223], v[52:55], v[84:87], v[220:223]
    v_mfma_f32_16x16x32_bf16 v[216:219], v[40:43], v[88:91], v[216:219]
    v_mfma_f32_16x16x32_bf16 v[220:223], v[56:59], v[88:91], v[220:223]
    v_exp_f32 v96, v208
    v_exp_f32 v97, v209
    v_exp_f32 v98, v210
    v_exp_f32 v99, v211
    v_exp_f32 v100, v212
    v_exp_f32 v101, v213
    v_exp_f32 v102, v214
    v_exp_f32 v103, v215
    v_fma_f32 v96, v96, s66, s66
    v_fma_f32 v97, v97, s66, s66
    v_fma_f32 v98, v98, s66, s66
    v_fma_f32 v99, v99, s66, s66
    v_fma_f32 v100, v100, s66, s66
    v_fma_f32 v101, v101, s66, s66
    v_fma_f32 v102, v102, s66, s66
    v_fma_f32 v103, v103, s66, s66
    v_rcp_f32 v96, v96
    v_rcp_f32 v97, v97
    v_rcp_f32 v98, v98
    v_rcp_f32 v99, v99
    v_rcp_f32 v100, v100
    v_rcp_f32 v101, v101
    v_rcp_f32 v102, v102
    v_rcp_f32 v103, v103
    v_exp_f32 v104, v216
    v_exp_f32 v105, v217
    v_exp_f32 v106, v218
    v_exp_f32 v107, v219
    v_exp_f32 v108, v220
    v_exp_f32 v109, v221
    v_exp_f32 v110, v222
    v_exp_f32 v111, v223
    v_pk_mul_f32 v[96:97], v[96:97], v[208:209]
    v_pk_mul_f32 v[98:99], v[98:99], v[210:211]
    v_pk_mul_f32 v[100:101], v[100:101], v[212:213]
    v_pk_mul_f32 v[102:103], v[102:103], v[214:215]
    v_cvt_pk_bf16_f32 v96, v96, v97
    v_cvt_pk_bf16_f32 v97, v98, v99
    v_cvt_pk_bf16_f32 v98, v100, v101
    v_cvt_pk_bf16_f32 v99, v102, v103
    ds_write_b128 v137, v[96:99] offset:0
    ds_read_b128 v[100:103], v139 offset:0
    v_pk_fma_f32 v[104:105], v[104:105], s[66:67], s[66:67]
    v_pk_fma_f32 v[106:107], v[106:107], s[66:67], s[66:67]
    v_pk_fma_f32 v[108:109], v[108:109], s[66:67], s[66:67]
    v_pk_fma_f32 v[110:111], v[110:111], s[66:67], s[66:67]
    v_rcp_f32 v104, v104
    v_rcp_f32 v105, v105
    v_rcp_f32 v106, v106
    v_rcp_f32 v107, v107
    v_rcp_f32 v108, v108
    v_rcp_f32 v109, v109
    v_rcp_f32 v110, v110
    v_rcp_f32 v111, v111
    s_waitcnt lgkmcnt(0)
    buffer_store_dwordx4 v[100:103], v140, s[28:31], s4 offen sc1
    v_pk_mul_f32 v[104:105], v[104:105], v[216:217]
    v_pk_mul_f32 v[106:107], v[106:107], v[218:219]
    v_pk_mul_f32 v[108:109], v[108:109], v[220:221]
    v_pk_mul_f32 v[110:111], v[110:111], v[222:223]
    v_cvt_pk_bf16_f32 v104, v104, v105
    v_cvt_pk_bf16_f32 v105, v106, v107
    v_cvt_pk_bf16_f32 v106, v108, v109
    v_cvt_pk_bf16_f32 v107, v110, v111
    ds_write_b128 v137, v[104:107] offset:1024
    ds_read_b128 v[108:111], v139 offset:1024
    s_branch KF_ej
KF_eg:
    v_mfma_f32_16x16x32_bf16 v[216:219], v[76:79], v[28:31], v[216:219]
    v_mfma_f32_16x16x32_bf16 v[220:223], v[76:79], v[44:47], v[220:223]
    v_mfma_f32_16x16x32_bf16 v[216:219], v[80:83], v[32:35], v[216:219]
    v_mfma_f32_16x16x32_bf16 v[220:223], v[80:83], v[48:51], v[220:223]
    v_mfma_f32_16x16x32_bf16 v[216:219], v[84:87], v[36:39], v[216:219]
    v_mfma_f32_16x16x32_bf16 v[220:223], v[84:87], v[52:55], v[220:223]
    v_mfma_f32_16x16x32_bf16 v[216:219], v[88:91], v[40:43], v[216:219]
    v_mfma_f32_16x16x32_bf16 v[220:223], v[88:91], v[56:59], v[220:223]
    v_exp_f32 v96, v208
    v_exp_f32 v97, v209
    v_exp_f32 v98, v210
    v_exp_f32 v99, v211
    v_exp_f32 v100, v212
    v_exp_f32 v101, v213
    v_exp_f32 v102, v214
    v_exp_f32 v103, v215
    v_exp_f32 v104, v216
    v_exp_f32 v108, v220
    v_pk_fma_f32 v[96:97], v[96:97], s[66:67], s[66:67]
    v_pk_fma_f32 v[98:99], v[98:99], s[66:67], s[66:67]
    v_pk_fma_f32 v[100:101], v[100:101], s[66:67], s[66:67]
    v_pk_fma_f32 v[102:103], v[102:103], s[66:67], s[66:67]
    v_pk_fma_f32 v[104:105], v[104:105], s[66:67], s[66:67]
    v_pk_fma_f32 v[108:109], v[108:109], s[66:67], s[66:67]
    v_rcp_f32 v96, v96
    v_rcp_f32 v97, v97
    v_rcp_f32 v98, v98
    v_rcp_f32 v99, v99
    v_rcp_f32 v100, v100
    v_rcp_f32 v101, v101
    v_rcp_f32 v102, v102
    v_rcp_f32 v103, v103
    v_rcp_f32 v104, v104
    v_rcp_f32 v108, v108
    v_pk_mul_f32 v[96:97], v[96:97], v[208:209]
    v_pk_mul_f32 v[98:99], v[98:99], v[210:211]
    v_pk_mul_f32 v[100:101], v[100:101], v[212:213]
    v_pk_mul_f32 v[102:103], v[102:103], v[214:215]
    v_cvt_pk_bf16_f32 v96, v96, v97
    v_cvt_pk_bf16_f32 v97, v98, v99
    v_cvt_pk_bf16_f32 v98, v100, v101
    v_cvt_pk_bf16_f32 v99, v102, v103
    ds_write_b128 v137, v[96:99] offset:0
    ds_read_b128 v[100:103], v139 offset:0
    v_mul_f32 v104, v104, v216
    v_mul_f32 v108, v108, v220
    s_mov_b64 exec, 0xffff
    v_cvt_pk_bf16_f32 v104, v104, v108
    ds_write_b16 v138, v104 offset:1024
    ds_write_b16_d16_hi v138, v104 offset:1032
    ds_read_b128 v[108:111], v139 offset:1024
    s_mov_b64 exec, -1
    s_waitcnt lgkmcnt(3)
    buffer_store_dwordx4 v[100:103], v140, s[28:31], s4 offen sc1
    s_mov_b64 exec, 15
KF_ej:
    s_waitcnt lgkmcnt(0)
    buffer_store_dwordx4 v[108:111], v140, s[28:31], s5 offen sc1
KF_END:
    s_endpgm
KF_lt:
    s_cmp_eq_u32 s64, s3
    s_cbranch_scc0 KF_lb
    s_lshl_b32 s84, s74, 6
    s_add_u32 m0, s61, 0
    s_add_u32 s85, s84, 32768
    buffer_load_dwordx4 v151, s[32:35], s85 offen lds
    s_add_u32 m0, s61, 1024
    s_add_u32 s85, s84, 36864
    buffer_load_dwordx4 v151, s[32:35], s85 offen lds
    s_add_u32 m0, s61, 2048
    s_add_u32 s85, s84, 40960
    buffer_load_dwordx4 v151, s[32:35], s85 offen lds
    s_add_u32 m0, s61, 3072
    s_add_u32 s85, s84, 45056
    buffer_load_dwordx4 v151, s[32:35], s85 offen lds
    s_add_u32 m0, s61, 4096
    s_add_u32 s85, s84, 49152
    buffer_load_dwordx4 v151, s[32:35], s85 offen lds
    s_add_u32 m0, s61, 5120
    s_add_u32 s85, s84, 53248
    buffer_load_dwordx4 v151, s[32:35], s85 offen lds
    s_add_u32 m0, s61, 6144
    s_add_u32 s85, s84, 57344
    buffer_load_dwordx4 v151, s[32:35], s85 offen lds
    s_add_u32 m0, s61, 7168
    s_add_u32 s85, s84, 61440
    buffer_load_dwordx4 v151, s[32:35], s85 offen lds
    s_branch KF_lb
KF_pr:
    s_setprio 2
    s_cmp_eq_u32 s64, 5
    s_cbranch_scc1 KF_pb
    s_setprio 1
    s_cmp_eq_u32 s64, 3
    s_cbranch_scc1 KF_pb
    s_cmp_ge_u32 s56, 8
    s_cbranch_scc1 KF_pb
    s_setprio 0
    s_branch KF_pb
KT_hr:
    s_sub_u32 s73, s73, 1
    s_cbranch_scc1 KT_hx
    s_sleep 4
    s_mov_b64 exec, s[54:55]
    s_cbranch_execz KT_hl7
    buffer_load_dwordx4 v[124:127], v251, s[36:39], s62 offen offset:3072 sc1
KT_hl7:
    s_mov_b64 exec, s[52:53]
    s_cbranch_execz KT_hl6
    buffer_load_dwordx4 v[120:123], v250, s[36:39], s62 offen offset:2048 sc1
KT_hl6:
    s_mov_b64 exec, s[50:51]
    s_cbranch_execz KT_hl5
    buffer_load_dwordx4 v[116:119], v249, s[36:39], s62 offen offset:1024 sc1
KT_hl5:
    s_mov_b64 exec, s[48:49]
    s_cbranch_execz KT_hl4
    buffer_load_dwordx4 v[112:115], v248, s[36:39], s62 offen offset:0 sc1
KT_hl4:
    s_mov_b64 exec, s[46:47]
    s_cbranch_execz KT_hl3
    buffer_load_dwordx4 v[108:111], v247, s[36:39], 0 offen offset:3072 sc1
KT_hl3:
    s_mov_b64 exec, s[44:45]
    s_cbranch_execz KT_hl2
    buffer_load_dwordx4 v[104:107], v246, s[36:39], 0 offen offset:2048 sc1
KT_hl2:
    s_mov_b64 exec, s[42:43]
    s_cbranch_execz KT_hl1
    buffer_load_dwordx4 v[100:103], v245, s[36:39], 0 offen offset:1024 sc1
KT_hl1:
    s_mov_b64 exec, s[40:41]
    s_cbranch_execz KT_hl0
    buffer_load_dwordx4 v[96:99], v244, s[36:39], 0 offen offset:0 sc1
KT_hl0:
    s_mov_b64 exec, -1
    s_waitcnt vmcnt(0)
    s_branch KT_hp
KT_hx:
    s_mov_b32 s73, 0
    s_mov_b64 exec, 1
    ds_add_u32 v238, v1 offset:292
    s_branch KT_hd
KF_CEND:
KF_SLOW:
    s_setprio 0
    s_cmp_ge_u32 s56, 4
    s_cselect_b32 s71, 0, s71
    v_mov_b32 v1, s71
    ds_max_u32 v238, v1 offset:284
    v_mov_b32 v124, 0
    v_mov_b32 v125, 0
    v_mov_b32 v126, 0
    v_mov_b32 v127, 0
    s_mov_b32 s77, 0
    s_mov_b32 s75, s61
    s_sub_u32 s84, s56, s65
    s_lshl_b32 s84, s84, 4
    v_add_u32 v164, s84, v152
    v_add_u32 v165, s84, v153
    s_lshl_b32 s84, s56, 4
    v_sub_u32 v166, s84, v156
    v_and_b32 v167, 28, v157
    v_and_b32 v1, 3, v157
    v_lshlrev_b32 v1, 2, v1
    v_lshl_or_b32 v167, v167, 3, v1
    v_lshlrev_b32 v1, 4, v0
    ds_write_b128 v1, v[124:127] offset:2144
    ds_write_b128 v1, v[124:127] offset:10336
    ds_write_b128 v1, v[124:127] offset:18528
    v_lshlrev_b32 v1, 4, v157
    ds_write_b128 v1, v[124:127] offset:26720
    s_waitcnt vmcnt(0) lgkmcnt(0)
    s_barrier
    ds_read_b32 v1, v238 offset:284
    s_waitcnt lgkmcnt(0)
    v_readfirstlane_b32 s70, v1
KF_SR:
    s_cmp_lt_u32 s77, s70
    s_cbranch_scc0 KF_SE
    s_barrier
    v_lshlrev_b32 v1, 2, v157
    v_lshlrev_b32 v2, 8, v157
    ds_write_b32 v1, v2
    s_waitcnt lgkmcnt(0)
    s_barrier
    s_cmp_ge_u32 s56, 4
    s_cbranch_scc1 KF_S1
    s_movk_i32 s87, 256
    v_subrev_u32 v1, s77, v243
    v_add_u32 v2, v1, v242
    v_med3_i32 v1, v1, 0, s87
    v_med3_i32 v2, v2, 0, s87
    v_sub_u32 v2, v2, v1
    v_lshl_add_u32 v1, v1, 2, s75
KF_x:
    v_cmpx_lt_i32 vcc, 0, v2
    ds_write_b32 v1, v241 offset:0
    v_cmpx_lt_i32 vcc, 1, v2
    ds_write_b32 v1, v241 offset:4
    v_cmpx_lt_i32 vcc, 2, v2
    ds_write_b32 v1, v241 offset:8
    v_cmpx_lt_i32 vcc, 3, v2
    ds_write_b32 v1, v241 offset:12
    v_cmpx_lt_i32 vcc, 4, v2
    ds_write_b32 v1, v241 offset:16
    v_cmpx_lt_i32 vcc, 5, v2
    ds_write_b32 v1, v241 offset:20
    v_cmpx_lt_i32 vcc, 6, v2
    ds_write_b32 v1, v241 offset:24
    v_cmpx_lt_i32 vcc, 7, v2
    ds_write_b32 v1, v241 offset:28
    v_cmpx_lt_i32 vcc, 8, v2
    ds_write_b32 v1, v241 offset:32
    v_cmpx_lt_i32 vcc, 9, v2
    ds_write_b32 v1, v241 offset:36
    v_cmpx_lt_i32 vcc, 10, v2
    ds_write_b32 v1, v241 offset:40
    v_cmpx_lt_i32 vcc, 11, v2
    ds_write_b32 v1, v241 offset:44
    v_cmpx_lt_i32 vcc, 12, v2
    ds_write_b32 v1, v241 offset:48
    v_cmpx_lt_i32 vcc, 13, v2
    s_cbranch_vccz KF_xz
    ds_write_b32 v1, v241 offset:52
    v_cmpx_lt_i32 vcc, 14, v2
    ds_write_b32 v1, v241 offset:56
    v_cmpx_lt_i32 vcc, 15, v2
    ds_write_b32 v1, v241 offset:60
    v_add_u32 v2, -16, v2
    v_add_u32 v1, 64, v1
    v_cmp_lt_i32 vcc, 0, v2
    s_cmp_lg_u64 vcc, 0
    s_cbranch_scc1 KF_x
KF_xz:
    s_mov_b64 exec, -1
    s_sub_u32 s85, s71, s77
    v_lshl_add_u32 v1, v157, 2, s75
    ds_read_b32 v247, v1 offset:768
    ds_read_b32 v246, v1 offset:512
    ds_read_b32 v245, v1 offset:256
    ds_read_b32 v244, v1 offset:0
    v_add_u32 v2, s77, v157
    v_lshlrev_b32 v2, 4, v2
    s_movk_i32 s62, 4096
    v_cmp_gt_i32 s[40:41], s85, v157
    s_sub_u32 s85, s85, 64
    v_cmp_gt_i32 s[42:43], s85, v157
    s_sub_u32 s85, s85, 64
    v_cmp_gt_i32 s[44:45], s85, v157
    s_sub_u32 s85, s85, 64
    v_cmp_gt_i32 s[46:47], s85, v157
    s_sub_u32 s85, s85, 64
    s_waitcnt lgkmcnt(0)
    v_add_u32 v244, v244, v2
    v_add_u32 v245, v245, v2
    v_add_u32 v246, v246, v2
    v_add_u32 v247, v247, v2
    s_mov_b64 exec, s[46:47]
    s_cbranch_execz KF_rl3
    buffer_load_dwordx4 v[108:111], v247, s[36:39], 0 offen offset:3072 sc1
KF_rl3:
    s_mov_b64 exec, s[44:45]
    s_cbranch_execz KF_rl2
    buffer_load_dwordx4 v[104:107], v246, s[36:39], 0 offen offset:2048 sc1
KF_rl2:
    s_mov_b64 exec, s[42:43]
    s_cbranch_execz KF_rl1
    buffer_load_dwordx4 v[100:103], v245, s[36:39], 0 offen offset:1024 sc1
KF_rl1:
    s_mov_b64 exec, s[40:41]
    s_cbranch_execz KF_rl0
    buffer_load_dwordx4 v[96:99], v244, s[36:39], 0 offen offset:0 sc1
KF_rl0:
    s_mov_b64 exec, -1
    s_mov_b64 s[48:49], s[40:41]
    s_mov_b64 s[50:51], s[42:43]
    s_mov_b64 s[52:53], s[44:45]
    s_mov_b64 s[54:55], s[46:47]
    v_mov_b32 v1, 4
    s_mov_b32 s63, 72976
KF_hp:
    s_mov_b64 exec, s[46:47]
    s_waitcnt vmcnt(3)
    v_cmpx_eq_u32 s[86:87], s72, v111
    v_lshrrev_b32 v111, 17, v110
    ds_add_rtn_u32 v247, v111, v1
    s_andn2_b64 s[46:47], s[46:47], s[86:87]
    s_mov_b64 vcc, s[46:47]
    s_mov_b64 exec, s[44:45]
    s_waitcnt vmcnt(2)
    v_cmpx_eq_u32 s[84:85], s72, v107
    v_lshrrev_b32 v107, 17, v106
    ds_add_rtn_u32 v246, v107, v1
    s_andn2_b64 s[44:45], s[44:45], s[84:85]
    s_or_b64 vcc, vcc, s[44:45]
    s_mov_b64 exec, s[42:43]
    s_waitcnt vmcnt(1)
    v_cmpx_eq_u32 s[86:87], s72, v103
    v_lshrrev_b32 v103, 17, v102
    ds_add_rtn_u32 v245, v103, v1
    s_andn2_b64 s[42:43], s[42:43], s[86:87]
    s_or_b64 vcc, vcc, s[42:43]
    s_mov_b64 exec, s[40:41]
    s_waitcnt vmcnt(0)
    v_cmpx_eq_u32 s[84:85], s72, v99
    v_lshrrev_b32 v99, 17, v98
    ds_add_rtn_u32 v244, v99, v1
    s_andn2_b64 s[40:41], s[40:41], s[84:85]
    s_or_b64 vcc, vcc, s[40:41]
    s_cbranch_vccnz KF_hr
KF_hd:
    s_mov_b64 exec, -1
    s_waitcnt lgkmcnt(0)
    v_mov_b32 v176, v96
    v_mov_b32 v177, v97
    v_mov_b32 v178, v98
    v_lshlrev_b32 v1, 6, v99
    v_sub_u32 v1, v244, v1
    v_cndmask_b32 v179, -1, v1, s[48:49]
    v_mov_b32 v180, v100
    v_mov_b32 v181, v101
    v_mov_b32 v182, v102
    v_lshlrev_b32 v1, 6, v103
    v_sub_u32 v1, v245, v1
    v_cndmask_b32 v183, -1, v1, s[50:51]
    v_mov_b32 v184, v104
    v_mov_b32 v185, v105
    v_mov_b32 v186, v106
    v_lshlrev_b32 v1, 6, v107
    v_sub_u32 v1, v246, v1
    v_cndmask_b32 v187, -1, v1, s[52:53]
    v_mov_b32 v188, v108
    v_mov_b32 v189, v109
    v_mov_b32 v190, v110
    v_lshlrev_b32 v1, 6, v111
    v_sub_u32 v1, v247, v1
    v_cndmask_b32 v191, -1, v1, s[54:55]
KF_S1:
    s_mov_b32 s82, 0
KF_SK:
    s_waitcnt lgkmcnt(0)
    s_barrier
    s_cmp_ge_u32 s56, 4
    s_cbranch_scc1 KF_S2
    s_mov_b32 s85, 72976
    v_subrev_u32 v1, s82, v179
    v_lshrrev_b32 v2, 19, v178
    v_lshl_add_u32 v2, v2, 8, v1
    v_lshl_add_u32 v3, v2, 1, s85
    v_cmpx_gt_u32 vcc, 0x100, v1
    ds_write_b32 v2, v178 offset:60416
    ds_write_b64 v3, v[176:177]
    s_mov_b64 exec, -1
    v_subrev_u32 v1, s82, v183
    v_lshrrev_b32 v2, 19, v182
    v_lshl_add_u32 v2, v2, 8, v1
    v_lshl_add_u32 v3, v2, 1, s85
    v_cmpx_gt_u32 vcc, 0x100, v1
    ds_write_b32 v2, v182 offset:60416
    ds_write_b64 v3, v[180:181]
    s_mov_b64 exec, -1
    v_subrev_u32 v1, s82, v187
    v_lshrrev_b32 v2, 19, v186
    v_lshl_add_u32 v2, v2, 8, v1
    v_lshl_add_u32 v3, v2, 1, s85
    v_cmpx_gt_u32 vcc, 0x100, v1
    ds_write_b32 v2, v186 offset:60416
    ds_write_b64 v3, v[184:185]
    s_mov_b64 exec, -1
    v_subrev_u32 v1, s82, v191
    v_lshrrev_b32 v2, 19, v190
    v_lshl_add_u32 v2, v2, 8, v1
    v_lshl_add_u32 v3, v2, 1, s85
    v_cmpx_gt_u32 vcc, 0x100, v1
    ds_write_b32 v2, v190 offset:60416
    ds_write_b64 v3, v[188:189]
    s_mov_b64 exec, -1
KF_S2:
    v_lshlrev_b32 v1, 2, v157
    ds_read_b32 v92, v1
    v_cmp_gt_u32 vcc, s58, v157
    v_lshlrev_b32 v93, 8, v157
    s_waitcnt lgkmcnt(0)
    v_sub_u32 v224, v92, v93
    s_movk_i32 s85, 256
    v_subrev_u32 v224, s82, v224
    v_cmp_lt_i32 s[86:87], s85, v224
    v_med3_i32 v224, v224, 0, s85
    v_add_u32 v92, v93, v224
    v_add_u32 v3, 12, v224
    v_and_b32 v3, -16, v3
    v_max_u32 v3, 80, v3
    v_cndmask_b32 v3, 0, v3, vcc
    v_mov_b32 v2, v3
    s_nop 1
    v_add_u32_dpp v2, v2, v2 row_shr:1 row_mask:0xf bank_mask:0xf bound_ctrl:0
    s_nop 1
    v_add_u32_dpp v2, v2, v2 row_shr:2 row_mask:0xf bank_mask:0xf bound_ctrl:0
    s_nop 1
    v_add_u32_dpp v2, v2, v2 row_shr:4 row_mask:0xf bank_mask:0xf bound_ctrl:0
    s_nop 1
    v_add_u32_dpp v2, v2, v2 row_shr:8 row_mask:0xf bank_mask:0xf bound_ctrl:0
    s_nop 1
    v_add_u32_dpp v2, v2, v2 row_bcast:15 row_mask:0xa bank_mask:0xf
    s_nop 1
    v_add_u32_dpp v2, v2, v2 row_bcast:31 row_mask:0xc bank_mask:0xf
    s_nop 1
    v_readlane_b32 s84, v2, 63
    v_sub_u32 v2, v2, v3
    s_cmp_lg_u64 s[86:87], 0
    s_cselect_b32 s76, 1, 0
    s_lshl_b32 s85, s56, 4
    v_add_u32 v225, s85, v2
    v_lshrrev_b32 v225, 3, v225
    v_add_u32 v93, s85, v93
    v_subrev_u32 v226, s85, v3
    v_cmpx_lt_i32 vcc, 0, v226
    ds_write_b16 v225, v93 offset:928
    v_add_u32 v94, 128, v93
    v_cmpx_lt_i32 vcc, 128, v226
    ds_write_b16 v225, v94 offset:944
    s_mov_b64 exec, -1
    s_lshl_b32 s85, s56, 2
    v_sub_u32 v226, v3, v224
    v_add_u32 v92, s85, v92
    v_subrev_u32 v226, s85, v226
    s_mov_b32 s85, 72976
    v_mov_b32 v228, 0
    v_mov_b32 v229, 0
    v_mov_b32 v230, 0x200ffff
    v_lshl_add_u32 v231, v92, 1, s85
    v_cmpx_lt_i32 vcc, 0, v226
    ds_write_b32 v92, v230 offset:60416
    ds_write_b64 v231, v[228:229] offset:0
    v_cmpx_lt_i32 vcc, 32, v226
    s_cbranch_vccz KFsp
    ds_write_b32 v92, v230 offset:60448
    ds_write_b64 v231, v[228:229] offset:64
    v_cmpx_lt_i32 vcc, 64, v226
    ds_write_b32 v92, v230 offset:60480
    ds_write_b64 v231, v[228:229] offset:128
KFsp:
    s_mov_b64 exec, -1
    s_cmp_eq_u32 s56, 3
    s_cbranch_scc0 KFsq
    s_lshr_b32 s85, s84, 3
    v_lshl_add_u32 v225, v157, 1, s85
    v_mov_b32 v226, 12544
    v_add_u32 v227, 12544, v1
    v_lshlrev_b32 v231, 1, v1
    v_add_u32 v231, 98064, v231
    s_mov_b64 exec, 0xff
    ds_write_b16 v225, v226 offset:928
    s_mov_b64 exec, 15
    ds_write_b32 v227, v230 offset:60416
    ds_write_b64 v231, v[228:229]
    s_mov_b64 exec, -1
KFsq:
    s_add_u32 s60, s84, 127
    s_lshr_b32 s60, s60, 7
    s_waitcnt lgkmcnt(0)
    s_barrier
    v_mov_b32 v152, v164
    v_mov_b32 v153, v165
    v_mov_b32 v172, v166
    s_mov_b32 s59, s56
KF_SL:
    s_cmp_lt_u32 s59, s60
    s_cbranch_scc0 KF_SN
    ds_read_u16 v232, v153 offset:928
    ds_read_u16 v234, v152 offset:928
    ds_read_u16 v168, v172 offset:928
    ds_read_u16 v169, v172 offset:930
    ds_read_u16 v170, v172 offset:932
    ds_read_u16 v171, v172 offset:934
    s_waitcnt lgkmcnt(0)
    v_lshl_add_u32 v235, v234, 1, v237
    v_add_u32 v234, v234, v236
    ds_read_u16 v155, v234 offset:60418
    ds_read_u16 v128, v232 offset:60416
    ds_read_u16 v130, v232 offset:60420
    ds_read_u16 v132, v232 offset:60424
    ds_read_u16 v134, v232 offset:60428
    s_waitcnt lgkmcnt(0)
    v_cmp_ne_u32 vcc, 0xffff, v128
    s_cbranch_vccz KF_SM
    s_mov_b32 m0, s61
    s_nop 0
    buffer_load_dwordx4 v[128:129], s[24:27], 0 idxen offen offset:0 sc1 lds
    buffer_load_dwordx4 v[130:131], s[24:27], 0 idxen offen offset:1024 sc1 lds
    buffer_load_dwordx4 v[132:133], s[24:27], 0 idxen offen offset:2048 sc1 lds
    buffer_load_dwordx4 v[134:135], s[24:27], 0 idxen offen offset:3072 sc1 lds
    s_add_u32 m0, s61, 4096
    s_nop 0
    buffer_load_dwordx4 v[128:129], s[24:27], s81 idxen offen offset:0 sc1 lds
    buffer_load_dwordx4 v[130:131], s[24:27], s81 idxen offen offset:1024 sc1 lds
    buffer_load_dwordx4 v[132:133], s[24:27], s81 idxen offen offset:2048 sc1 lds
    buffer_load_dwordx4 v[134:135], s[24:27], s81 idxen offen offset:3072 sc1 lds
    v_lshrrev_b32 v168, 8, v168
    v_lshrrev_b32 v169, 8, v169
    v_lshrrev_b32 v170, 8, v170
    v_lshrrev_b32 v171, 8, v171
    v_readfirstlane_b32 s62, v168
    s_nop 3
    s_and_b32 s62, s62, -2
    s_lshl_b32 s62, s62, 3
    s_sub_u32 s63, 0, s62
    v_add3_u32 v155, v155, v150, s63
    v_lshl_add_u32 v250, s62, 6, v145
    ds_read_b128 v[14:17], v250
    ds_read_b128 v[22:25], v250 offset:512
    ds_read_b64 v[244:245], v235
    ds_read_b64 v[246:247], v155 offset:400
    ds_read_b64 v[248:249], v235
    v_lshl_add_u32 v168, v168, 9, v167
    v_lshl_add_u32 v169, v169, 9, v167
    v_lshl_add_u32 v170, v170, 9, v167
    v_lshl_add_u32 v171, v171, 9, v167
    s_waitcnt vmcnt(0) lgkmcnt(0)
    ds_read_b128 v[28:31], v144 offset:0
    ds_read_b128 v[32:35], v144 offset:2048
    ds_read_b128 v[36:39], v144 offset:256
    ds_read_b128 v[40:43], v144 offset:2304
    ds_read_b128 v[44:47], v144 offset:4096
    ds_read_b128 v[48:51], v144 offset:6144
    ds_read_b128 v[52:55], v144 offset:4352
    ds_read_b128 v[56:59], v144 offset:6400
    s_waitcnt lgkmcnt(0)
    v_mfma_f32_4x4x4_16b_bf16 v[60:63], v[28:29], v[4:5], 0
    v_mfma_f32_4x4x4_16b_bf16 v[64:67], v[32:33], v[4:5], 0
    v_mfma_f32_4x4x4_16b_bf16 v[68:71], v[36:37], v[4:5], 0
    v_mfma_f32_4x4x4_16b_bf16 v[72:75], v[40:41], v[4:5], 0
    s_nop 3
    v_mfma_f32_32x32x16_bf16 v[60:75], v[244:247], v[12:15], v[60:75]
    s_nop 15
    v_exp_f32 v96, v60
    v_exp_f32 v97, v61
    v_exp_f32 v98, v62
    v_exp_f32 v99, v63
    v_exp_f32 v100, v64
    v_exp_f32 v101, v65
    v_exp_f32 v102, v66
    v_exp_f32 v103, v67
    v_exp_f32 v104, v68
    v_exp_f32 v105, v69
    v_exp_f32 v106, v70
    v_exp_f32 v107, v71
    v_exp_f32 v108, v72
    v_exp_f32 v109, v73
    v_exp_f32 v110, v74
    v_exp_f32 v111, v75
    v_add_f32 v96, 1.0, v96
    v_add_f32 v97, 1.0, v97
    v_add_f32 v98, 1.0, v98
    v_add_f32 v99, 1.0, v99
    v_add_f32 v100, 1.0, v100
    v_add_f32 v101, 1.0, v101
    v_add_f32 v102, 1.0, v102
    v_add_f32 v103, 1.0, v103
    v_add_f32 v104, 1.0, v104
    v_add_f32 v105, 1.0, v105
    v_add_f32 v106, 1.0, v106
    v_add_f32 v107, 1.0, v107
    v_add_f32 v108, 1.0, v108
    v_add_f32 v109, 1.0, v109
    v_add_f32 v110, 1.0, v110
    v_add_f32 v111, 1.0, v111
    v_rcp_f32 v96, v96
    v_rcp_f32 v97, v97
    v_rcp_f32 v98, v98
    v_rcp_f32 v99, v99
    v_rcp_f32 v100, v100
    v_rcp_f32 v101, v101
    v_rcp_f32 v102, v102
    v_rcp_f32 v103, v103
    v_rcp_f32 v104, v104
    v_rcp_f32 v105, v105
    v_rcp_f32 v106, v106
    v_rcp_f32 v107, v107
    v_rcp_f32 v108, v108
    v_rcp_f32 v109, v109
    v_rcp_f32 v110, v110
    v_rcp_f32 v111, v111
    v_mul_f32 v120, v60, v96
    v_mul_f32 v121, v61, v97
    v_mul_f32 v122, v68, v104
    v_mul_f32 v123, v69, v105
    v_fmac_f32 v120, v62, v98
    v_fmac_f32 v121, v63, v99
    v_fmac_f32 v122, v70, v106
    v_fmac_f32 v123, v71, v107
    v_fmac_f32 v120, v64, v100
    v_fmac_f32 v121, v65, v101
    v_fmac_f32 v122, v72, v108
    v_fmac_f32 v123, v73, v109
    v_fmac_f32 v120, v66, v102
    v_fmac_f32 v121, v67, v103
    v_fmac_f32 v122, v74, v110
    v_fmac_f32 v123, v75, v111
    ds_add_f32 v168, v120 offset:2144
    ds_add_f32 v169, v121 offset:2144
    ds_add_f32 v170, v122 offset:2144
    ds_add_f32 v171, v123 offset:2144
    s_waitcnt lgkmcnt(0)
    v_mfma_f32_4x4x4_16b_bf16 v[60:63], v[30:31], v[4:5], 0
    v_mfma_f32_4x4x4_16b_bf16 v[64:67], v[34:35], v[4:5], 0
    v_mfma_f32_4x4x4_16b_bf16 v[68:71], v[38:39], v[4:5], 0
    v_mfma_f32_4x4x4_16b_bf16 v[72:75], v[42:43], v[4:5], 0
    s_nop 3
    v_mfma_f32_32x32x16_bf16 v[60:75], v[246:249], v[16:19], v[60:75]
    s_nop 15
    v_exp_f32 v96, v60
    v_exp_f32 v97, v61
    v_exp_f32 v98, v62
    v_exp_f32 v99, v63
    v_exp_f32 v100, v64
    v_exp_f32 v101, v65
    v_exp_f32 v102, v66
    v_exp_f32 v103, v67
    v_exp_f32 v104, v68
    v_exp_f32 v105, v69
    v_exp_f32 v106, v70
    v_exp_f32 v107, v71
    v_exp_f32 v108, v72
    v_exp_f32 v109, v73
    v_exp_f32 v110, v74
    v_exp_f32 v111, v75
    v_add_f32 v96, 1.0, v96
    v_add_f32 v97, 1.0, v97
    v_add_f32 v98, 1.0, v98
    v_add_f32 v99, 1.0, v99
    v_add_f32 v100, 1.0, v100
    v_add_f32 v101, 1.0, v101
    v_add_f32 v102, 1.0, v102
    v_add_f32 v103, 1.0, v103
    v_add_f32 v104, 1.0, v104
    v_add_f32 v105, 1.0, v105
    v_add_f32 v106, 1.0, v106
    v_add_f32 v107, 1.0, v107
    v_add_f32 v108, 1.0, v108
    v_add_f32 v109, 1.0, v109
    v_add_f32 v110, 1.0, v110
    v_add_f32 v111, 1.0, v111
    v_rcp_f32 v96, v96
    v_rcp_f32 v97, v97
    v_rcp_f32 v98, v98
    v_rcp_f32 v99, v99
    v_rcp_f32 v100, v100
    v_rcp_f32 v101, v101
    v_rcp_f32 v102, v102
    v_rcp_f32 v103, v103
    v_rcp_f32 v104, v104
    v_rcp_f32 v105, v105
    v_rcp_f32 v106, v106
    v_rcp_f32 v107, v107
    v_rcp_f32 v108, v108
    v_rcp_f32 v109, v109
    v_rcp_f32 v110, v110
    v_rcp_f32 v111, v111
    v_mul_f32 v120, v60, v96
    v_mul_f32 v121, v61, v97
    v_mul_f32 v122, v68, v104
    v_mul_f32 v123, v69, v105
    v_fmac_f32 v120, v62, v98
    v_fmac_f32 v121, v63, v99
    v_fmac_f32 v122, v70, v106
    v_fmac_f32 v123, v71, v107
    v_fmac_f32 v120, v64, v100
    v_fmac_f32 v121, v65, v101
    v_fmac_f32 v122, v72, v108
    v_fmac_f32 v123, v73, v109
    v_fmac_f32 v120, v66, v102
    v_fmac_f32 v121, v67, v103
    v_fmac_f32 v122, v74, v110
    v_fmac_f32 v123, v75, v111
    ds_add_f32 v168, v120 offset:2160
    ds_add_f32 v169, v121 offset:2160
    ds_add_f32 v170, v122 offset:2160
    ds_add_f32 v171, v123 offset:2160
    s_waitcnt lgkmcnt(0)
    v_mfma_f32_4x4x4_16b_bf16 v[60:63], v[44:45], v[4:5], 0
    v_mfma_f32_4x4x4_16b_bf16 v[64:67], v[48:49], v[4:5], 0
    v_mfma_f32_4x4x4_16b_bf16 v[68:71], v[52:53], v[4:5], 0
    v_mfma_f32_4x4x4_16b_bf16 v[72:75], v[56:57], v[4:5], 0
    s_nop 3
    v_mfma_f32_32x32x16_bf16 v[60:75], v[244:247], v[20:23], v[60:75]
    s_nop 15
    v_exp_f32 v96, v60
    v_exp_f32 v97, v61
    v_exp_f32 v98, v62
    v_exp_f32 v99, v63
    v_exp_f32 v100, v64
    v_exp_f32 v101, v65
    v_exp_f32 v102, v66
    v_exp_f32 v103, v67
    v_exp_f32 v104, v68
    v_exp_f32 v105, v69
    v_exp_f32 v106, v70
    v_exp_f32 v107, v71
    v_exp_f32 v108, v72
    v_exp_f32 v109, v73
    v_exp_f32 v110, v74
    v_exp_f32 v111, v75
    v_add_f32 v96, 1.0, v96
    v_add_f32 v97, 1.0, v97
    v_add_f32 v98, 1.0, v98
    v_add_f32 v99, 1.0, v99
    v_add_f32 v100, 1.0, v100
    v_add_f32 v101, 1.0, v101
    v_add_f32 v102, 1.0, v102
    v_add_f32 v103, 1.0, v103
    v_add_f32 v104, 1.0, v104
    v_add_f32 v105, 1.0, v105
    v_add_f32 v106, 1.0, v106
    v_add_f32 v107, 1.0, v107
    v_add_f32 v108, 1.0, v108
    v_add_f32 v109, 1.0, v109
    v_add_f32 v110, 1.0, v110
    v_add_f32 v111, 1.0, v111
    v_rcp_f32 v96, v96
    v_rcp_f32 v97, v97
    v_rcp_f32 v98, v98
    v_rcp_f32 v99, v99
    v_rcp_f32 v100, v100
    v_rcp_f32 v101, v101
    v_rcp_f32 v102, v102
    v_rcp_f32 v103, v103
    v_rcp_f32 v104, v104
    v_rcp_f32 v105, v105
    v_rcp_f32 v106, v106
    v_rcp_f32 v107, v107
    v_rcp_f32 v108, v108
    v_rcp_f32 v109, v109
    v_rcp_f32 v110, v110
    v_rcp_f32 v111, v111
    v_mul_f32 v120, v60, v96
    v_mul_f32 v121, v61, v97
    v_mul_f32 v122, v68, v104
    v_mul_f32 v123, v69, v105
    v_fmac_f32 v120, v62, v98
    v_fmac_f32 v121, v63, v99
    v_fmac_f32 v122, v70, v106
    v_fmac_f32 v123, v71, v107
    v_fmac_f32 v120, v64, v100
    v_fmac_f32 v121, v65, v101
    v_fmac_f32 v122, v72, v108
    v_fmac_f32 v123, v73, v109
    v_fmac_f32 v120, v66, v102
    v_fmac_f32 v121, v67, v103
    v_fmac_f32 v122, v74, v110
    v_fmac_f32 v123, v75, v111
    ds_add_f32 v168, v120 offset:2400
    ds_add_f32 v169, v121 offset:2400
    ds_add_f32 v170, v122 offset:2400
    ds_add_f32 v171, v123 offset:2400
    s_waitcnt lgkmcnt(0)
    v_mfma_f32_4x4x4_16b_bf16 v[60:63], v[46:47], v[4:5], 0
    v_mfma_f32_4x4x4_16b_bf16 v[64:67], v[50:51], v[4:5], 0
    v_mfma_f32_4x4x4_16b_bf16 v[68:71], v[54:55], v[4:5], 0
    v_mfma_f32_4x4x4_16b_bf16 v[72:75], v[58:59], v[4:5], 0
    s_nop 3
    v_mfma_f32_32x32x16_bf16 v[60:75], v[246:249], v[24:27], v[60:75]
    s_nop 15
    v_exp_f32 v96, v60
    v_exp_f32 v97, v61
    v_exp_f32 v98, v62
    v_exp_f32 v99, v63
    v_exp_f32 v100, v64
    v_exp_f32 v101, v65
    v_exp_f32 v102, v66
    v_exp_f32 v103, v67
    v_exp_f32 v104, v68
    v_exp_f32 v105, v69
    v_exp_f32 v106, v70
    v_exp_f32 v107, v71
    v_exp_f32 v108, v72
    v_exp_f32 v109, v73
    v_exp_f32 v110, v74
    v_exp_f32 v111, v75
    v_add_f32 v96, 1.0, v96
    v_add_f32 v97, 1.0, v97
    v_add_f32 v98, 1.0, v98
    v_add_f32 v99, 1.0, v99
    v_add_f32 v100, 1.0, v100
    v_add_f32 v101, 1.0, v101
    v_add_f32 v102, 1.0, v102
    v_add_f32 v103, 1.0, v103
    v_add_f32 v104, 1.0, v104
    v_add_f32 v105, 1.0, v105
    v_add_f32 v106, 1.0, v106
    v_add_f32 v107, 1.0, v107
    v_add_f32 v108, 1.0, v108
    v_add_f32 v109, 1.0, v109
    v_add_f32 v110, 1.0, v110
    v_add_f32 v111, 1.0, v111
    v_rcp_f32 v96, v96
    v_rcp_f32 v97, v97
    v_rcp_f32 v98, v98
    v_rcp_f32 v99, v99
    v_rcp_f32 v100, v100
    v_rcp_f32 v101, v101
    v_rcp_f32 v102, v102
    v_rcp_f32 v103, v103
    v_rcp_f32 v104, v104
    v_rcp_f32 v105, v105
    v_rcp_f32 v106, v106
    v_rcp_f32 v107, v107
    v_rcp_f32 v108, v108
    v_rcp_f32 v109, v109
    v_rcp_f32 v110, v110
    v_rcp_f32 v111, v111
    v_mul_f32 v120, v60, v96
    v_mul_f32 v121, v61, v97
    v_mul_f32 v122, v68, v104
    v_mul_f32 v123, v69, v105
    v_fmac_f32 v120, v62, v98
    v_fmac_f32 v121, v63, v99
    v_fmac_f32 v122, v70, v106
    v_fmac_f32 v123, v71, v107
    v_fmac_f32 v120, v64, v100
    v_fmac_f32 v121, v65, v101
    v_fmac_f32 v122, v72, v108
    v_fmac_f32 v123, v73, v109
    v_fmac_f32 v120, v66, v102
    v_fmac_f32 v121, v67, v103
    v_fmac_f32 v122, v74, v110
    v_fmac_f32 v123, v75, v111
    ds_add_f32 v168, v120 offset:2416
    ds_add_f32 v169, v121 offset:2416
    ds_add_f32 v170, v122 offset:2416
    ds_add_f32 v171, v123 offset:2416
    s_waitcnt lgkmcnt(0)
KF_SM:
    v_add_u32 v153, 128, v153
    v_add_u32 v152, 128, v152
    v_add_u32 v172, 128, v172
    s_add_u32 s59, s59, 8
    s_branch KF_SL
KF_SN:
    s_add_u32 s82, s82, 256
    s_cmp_lg_u32 s76, 0
    s_cbranch_scc1 KF_SK
    s_add_u32 s77, s77, 256
    s_branch KF_SR
KF_SE:
    s_cmp_ge_u32 s56, 4
    s_cbranch_scc1 KF_SE2
    s_lshl_b32 s84, s74, 6
    s_add_u32 m0, s61, 0
    s_add_u32 s85, s84, 32768
    buffer_load_dwordx4 v151, s[32:35], s85 offen lds
    s_add_u32 m0, s61, 1024
    s_add_u32 s85, s84, 36864
    buffer_load_dwordx4 v151, s[32:35], s85 offen lds
    s_add_u32 m0, s61, 2048
    s_add_u32 s85, s84, 40960
    buffer_load_dwordx4 v151, s[32:35], s85 offen lds
    s_add_u32 m0, s61, 3072
    s_add_u32 s85, s84, 45056
    buffer_load_dwordx4 v151, s[32:35], s85 offen lds
    s_add_u32 m0, s61, 4096
    s_add_u32 s85, s84, 49152
    buffer_load_dwordx4 v151, s[32:35], s85 offen lds
    s_add_u32 m0, s61, 5120
    s_add_u32 s85, s84, 53248
    buffer_load_dwordx4 v151, s[32:35], s85 offen lds
    s_add_u32 m0, s61, 6144
    s_add_u32 s85, s84, 57344
    buffer_load_dwordx4 v151, s[32:35], s85 offen lds
    s_add_u32 m0, s61, 7168
    s_add_u32 s85, s84, 61440
    buffer_load_dwordx4 v151, s[32:35], s85 offen lds
KF_SE2:
    v_lshlrev_b32 v1, 4, v0
    v_lshrrev_b32 v2, 5, v0
    s_waitcnt vmcnt(0) lgkmcnt(0)
    s_barrier
    ds_read_b128 v[28:31], v1 offset:2144
    ds_read_b128 v[32:35], v1 offset:10336
    ds_read_b128 v[36:39], v1 offset:18528
    ds_read_b128 v[40:43], v1 offset:26720
    v_mul_u32_u24 v2, 272, v2
    v_and_b32 v3, 31, v0
    v_lshl_add_u32 v4, v3, 3, v2
    s_waitcnt lgkmcnt(0)
    s_barrier
    v_cvt_pk_bf16_f32 v28, v28, v29
    v_cvt_pk_bf16_f32 v29, v30, v31
    ds_write_b64 v4, v[28:29] offset:17408
    v_cvt_pk_bf16_f32 v32, v32, v33
    v_cvt_pk_bf16_f32 v33, v34, v35
    ds_write_b64 v4, v[32:33] offset:21760
    v_cvt_pk_bf16_f32 v36, v36, v37
    v_cvt_pk_bf16_f32 v37, v38, v39
    ds_write_b64 v4, v[36:37] offset:26112
    v_cvt_pk_bf16_f32 v40, v40, v41
    v_cvt_pk_bf16_f32 v41, v42, v43
    ds_write_b64 v4, v[40:41] offset:30464
    ds_read_b64_tr_b16 v[28:29], v143 offset:0
    ds_read_b64_tr_b16 v[30:31], v143 offset:256
    ds_read_b64_tr_b16 v[32:33], v143 offset:2048
    ds_read_b64_tr_b16 v[34:35], v143 offset:2304
    ds_read_b64_tr_b16 v[36:37], v143 offset:4096
    ds_read_b64_tr_b16 v[38:39], v143 offset:4352
    ds_read_b64_tr_b16 v[40:41], v143 offset:6144
    ds_read_b64_tr_b16 v[42:43], v143 offset:6400
    ds_read_b64_tr_b16 v[44:45], v143 offset:8
    ds_read_b64_tr_b16 v[46:47], v143 offset:264
    ds_read_b64_tr_b16 v[48:49], v143 offset:2056
    ds_read_b64_tr_b16 v[50:51], v143 offset:2312
    ds_read_b64_tr_b16 v[52:53], v143 offset:4104
    ds_read_b64_tr_b16 v[54:55], v143 offset:4360
    ds_read_b64_tr_b16 v[56:57], v143 offset:6152
    ds_read_b64_tr_b16 v[58:59], v143 offset:6408
    s_branch KF_FIN
KF_hr:
    s_sub_u32 s73, s73, 1
    s_cbranch_scc1 KF_hx
    s_sleep 4
    s_mov_b64 exec, s[46:47]
    s_cbranch_execz KF_hl3
    buffer_load_dwordx4 v[108:111], v247, s[36:39], 0 offen offset:3072 sc1
KF_hl3:
    s_mov_b64 exec, s[44:45]
    s_cbranch_execz KF_hl2
    buffer_load_dwordx4 v[104:107], v246, s[36:39], 0 offen offset:2048 sc1
KF_hl2:
    s_mov_b64 exec, s[42:43]
    s_cbranch_execz KF_hl1
    buffer_load_dwordx4 v[100:103], v245, s[36:39], 0 offen offset:1024 sc1
KF_hl1:
    s_mov_b64 exec, s[40:41]
    s_cbranch_execz KF_hl0
    buffer_load_dwordx4 v[96:99], v244, s[36:39], 0 offen offset:0 sc1
KF_hl0:
    s_mov_b64 exec, -1
    s_waitcnt vmcnt(0)
    s_branch KF_hp
KF_hx:
    s_mov_b32 s73, 0
    s_branch KF_hd
.section .rodata,"a"
.p2align 6
.amdhsa_kernel standalone__mpnn_edge_mlp__graph_kernel
  .amdhsa_next_free_vgpr 256
  .amdhsa_next_free_sgpr 102
  .amdhsa_accum_offset 256
  .amdhsa_group_segment_fixed_size 0
  .amdhsa_kernarg_size 72
  .amdhsa_user_sgpr_count 2
  .amdhsa_user_sgpr_kernarg_segment_ptr 1
  .amdhsa_system_sgpr_workgroup_id_x 1
  .amdhsa_float_denorm_mode_32 3
.end_amdhsa_kernel
```
